```python
import torch

def _softmax(x, axis=-1):
    return torch.softmax(x, dim=axis)

def _gelu(x):
    return torch.nn.functional.gelu(x, approximate='tanh')

def _silu(x):
    return torch.nn.functional.silu(x)

def _sigmoid(x):
    return torch.sigmoid(x)

def _layernorm(x, axis=-1, eps=1e-05):
    m = x.mean(dim=axis, keepdim=True)
    v = x.var(dim=axis, keepdim=True, unbiased=False)
    return (x - m) / torch.sqrt(v + eps)

def _scatter_add(tgt, idx, src, axis=0):
    return tgt.clone().index_add_(axis, idx, src)

def _segment_sum(src, seg, n):
    out = torch.zeros((n,) + src.shape[1:], dtype=src.dtype)
    return out.index_add_(0, seg, src)

def _pad(x, pw):
    flat = tuple((v for pair in reversed(pw) for v in pair))
    return torch.nn.functional.pad(x, flat)
kernel_name = 'concat_heads__ssm_conv_h3__memory_aug_recurrent_mem_tr__prompt'

def setup_inputs():

    _w = lambda a: (lambda t: t.to(torch.bfloat16) if t.is_floating_point() else t)(torch.as_tensor(a))

    def _A_setup():
        B, S, D = (1, 2048, 512)
        ks = 4
        return {'q': _w((lambda *s: torch.randn(*s, dtype=torch.bfloat16) * 0.05)(B, S, D)), 'k': _w((lambda *s: torch.randn(*s, dtype=torch.bfloat16) * 0.4)(B, S, D)), 'v': _w((lambda *s: torch.randn(*s, dtype=torch.bfloat16) * 0.4)(B, S, D)), 'shift_k': _w((lambda *s: torch.randn(*s, dtype=torch.bfloat16) * 0.4)(D, ks) * 0.5), 'ssm_k': _w((lambda *s: torch.randn(*s, dtype=torch.bfloat16) * 0.4)(D, S) * (1.0 / S ** 0.5)), 'ssm_D': _w((lambda *s: torch.randn(*s, dtype=torch.bfloat16) * 0.4)(D))}
    _A_in = _A_setup()

    def _B_setup():
        B, S, Dm = (1, 2048, 512)
        H, Dh = (32, 128)
        M, seg = (8, 32)
        seg = min(seg, S)
        S = S // seg * seg
        return {'x': _w((lambda *s: torch.randn(*s, dtype=torch.bfloat16) * 0.05)(B, S, Dm)), 'mem0': _w((lambda *s: torch.randn(*s, dtype=torch.bfloat16) * 0.4)(B, M, Dm)), 'Wq': _w((lambda *s: torch.randn(*s, dtype=torch.bfloat16) * 6.4)(Dm, H, Dh) * Dm ** (-0.5)), 'Wk': _w((lambda *s: torch.randn(*s, dtype=torch.bfloat16) * 6.4)(Dm, H, Dh) * Dm ** (-0.5)), 'Wv': _w((lambda *s: torch.randn(*s, dtype=torch.bfloat16) * 0.4)(Dm, H, Dh) * Dm ** (-0.5)), 'Wo': _w((lambda *s: torch.randn(*s, dtype=torch.bfloat16) * 0.4)(H, Dh, Dm) * (H * Dh) ** (-0.5)), 'seg_len': seg}
    _B_in = _B_setup()
    return {'A_q': _A_in['q'], 'A_k': _A_in['k'], 'A_v': _A_in['v'], 'A_shift_k': _A_in['shift_k'], 'A_ssm_k': _A_in['ssm_k'], 'A_ssm_D': _A_in['ssm_D'], 'B_x': _B_in['x'], 'B_mem0': _B_in['mem0'], 'B_Wq': _B_in['Wq'], 'B_Wk': _B_in['Wk'], 'B_Wv': _B_in['Wv'], 'B_Wo': _B_in['Wo'], 'B_seg_len': _B_in['seg_len']}

def reference(A_q, A_k, A_v, A_shift_k, A_ssm_k, A_ssm_D, B_x, B_mem0, B_Wq, B_Wk, B_Wv, B_Wo, B_seg_len):

    def _A_ref(q, k, v, shift_k, ssm_k, ssm_D):
        B, S, D = q.shape
        ks = shift_k.shape[-1]
        k_pad = _pad(k, ((0, 0), (ks - 1, 0), (0, 0)))
        k_shift = torch.zeros_like(k)
        for t in range(ks):
            k_shift = k_shift + k_pad[:, t:t + S, :] * shift_k[:, ks - 1 - t][None, None, :]
        kv = k_shift * v
        L = 2 * S
        kv_pad = _pad(kv, ((0, 0), (0, S), (0, 0)))
        kf_pad = _pad(ssm_k, ((0, 0), (0, S)))
        kv_f = (lambda x, axes=(-2, -1): torch.fft.rfft2(x.float(), dim=axes))(kv_pad[:, None, :, :], axes=(1, 2))
        kf_f = (lambda x, axes=(-2, -1): torch.fft.rfft2(x.float(), dim=axes))(kf_pad[:, None, :], axes=(1, 2))
        kf_f = (lambda x, *d: x.permute(*d))(kf_f, 1, 2, 0)
        y_f = kv_f * kf_f[None, :, :, :]
        y = (lambda x, s, axes=(-2, -1): torch.fft.irfft2(x, s=s, dim=axes).to(torch.bfloat16))(y_f, (1, L), axes=(1, 2))[:, 0, :S, :]
        y = y + kv * ssm_D[None, None, :]
        return q * y

    def _B_ref(x, mem0, Wq, Wk, Wv, Wo, seg_len):
        B, S, Dm = x.shape
        H, Dh = (Wq.shape[1], Wq.shape[2])
        M = mem0.shape[1]
        scale = Dh ** (-0.5)
        n_seg = S // seg_len
        L = M + seg_len
        idx = torch.arange(L)
        mask = (idx[:, None] < M) | (idx[:, None] >= idx[None, :])
        mem = mem0
        outs = []
        for s in range(n_seg):
            xs = x[:, s * seg_len:(s + 1) * seg_len, :].clone()
            h = torch.concatenate([mem, xs], axis=1)
            q = torch.einsum('btd,dhe->bhte', h, Wq)
            k = torch.einsum('btd,dhe->bhte', h, Wk)
            v = torch.einsum('btd,dhe->bhte', h, Wv)
            scores = torch.einsum('bhqe,bhke->bhqk', q, k) * scale
            scores = torch.where(mask[None, None], scores, -1000000000.0)
            p = _softmax(scores, axis=-1)
            o = torch.einsum('bhqk,bhke->bhqe', p, v)
            o = torch.einsum('bhte,hed->btd', o, Wo)
            mem = o[:, :M, :].clone()
            outs.append(o[:, M:, :])
        return torch.concatenate(outs, axis=1)
    a = _A_ref(A_q, A_k, A_v, A_shift_k, A_ssm_k, A_ssm_D)
    b = _B_ref(B_x, B_mem0, B_Wq, B_Wk, B_Wv, B_Wo, B_seg_len)
    return torch.concatenate([a, b], axis=-1)
```

```asm
; @launch grid=(256,1,1) block=(256,1,1) lds=163840
.amdgcn_target "amdgcn-amd-amdhsa--gfx950"
.text
.globl concat_heads__ssm_conv_h3__memory_aug_recurrent_mem_tr__prompt_kernel
.p2align 8
.type concat_heads__ssm_conv_h3__memory_aug_recurrent_mem_tr__prompt_kernel,@function
concat_heads__ssm_conv_h3__memory_aug_recurrent_mem_tr__prompt_kernel:
    s_cmp_ge_u32 s2, 256
    s_cbranch_scc1 L_end
    s_load_dwordx2 s[24:25], s[0:1], 112
    s_load_dwordx2 s[28:29], s[0:1], 120
    s_load_dwordx4 s[56:59], s[0:1], 64
    s_load_dwordx4 s[60:63], s[0:1], 80
    s_getreg_b32 s20, hwreg(HW_REG_XCC_ID)
    s_and_b32 s20, s20, 15
    v_lshrrev_b32 v1, 6, v0
    s_nop 0
    v_readfirstlane_b32 s21, v1
    v_and_b32 v30, 63, v0
    s_mov_b64 s[26:27], exec
    s_waitcnt lgkmcnt(0)
    s_mov_b32 s4, s28
    s_mov_b32 s5, s29
    s_mov_b32 s6, 0x10000000
    s_mov_b32 s7, 0x20000
    s_cmp_lg_u32 s21, 0
    s_cbranch_scc1 L_roles_wait
    s_mov_b64 exec, 1
    s_and_b32 s28, s20, 3
    s_lshl_b32 s28, s28, 6
    s_lshr_b32 s29, s20, 2
    s_lshl_b32 s29, s29, 2
    s_add_u32 s28, s28, s29
    v_mov_b32 v3, s28
    v_mov_b32 v4, 1
    global_atomic_add v5, v3, v4, s[24:25] sc0 sc1
    s_waitcnt vmcnt(0)
    v_mov_b32 v3, 162816
    ds_write_b32 v3, v5
    s_waitcnt lgkmcnt(0)
    s_mov_b64 exec, s[26:27]
L_roles_wait:
    s_barrier
    v_mov_b32 v3, 162816
    ds_read_b32 v4, v3
    s_waitcnt lgkmcnt(0)
    v_readfirstlane_b32 s22, v4
    s_mov_b32 s23, s20
    s_barrier
    s_cmp_ge_u32 s22, 32
    s_cbranch_scc1 L_end
    s_cmp_ge_u32 s23, 8
    s_cbranch_scc1 L_end
    s_lshl_b32 s97, s22, 13
    s_lshl_b32 s98, s22, 8
    s_cmp_eq_u32 s23, 0
    s_cbranch_scc1 L_chain
    s_branch L_xteam
L_chain:
    v_lshlrev_b32 v0, 4, v30
    s_mul_i32 s28, s21, 28672
    v_add_u32 v5, s28, v0
    v_and_b32 v32, 15, v30
    v_lshlrev_b32 v32, 5, v32
    v_lshrrev_b32 v33, 4, v30
    v_lshlrev_b32 v33, 3, v33
    v_add_u32 v32, v32, v33
    s_lshl_b32 s28, s21, 10
    s_add_u32 s28, s28, 155648
    v_add_u32 v1, s28, v32
    v_lshrrev_b32 v32, 5, v30
    v_lshlrev_b32 v32, 8, v32
    v_bfe_u32 v33, v30, 2, 2
    v_lshlrev_b32 v33, 6, v33
    v_add_u32 v32, v32, v33
    v_and_b32 v33, 1, v30
    v_lshlrev_b32 v33, 5, v33
    v_add_u32 v32, v32, v33
    v_bfe_u32 v33, v30, 4, 1
    v_lshlrev_b32 v33, 3, v33
    v_add_u32 v32, v32, v33
    s_lshr_b32 s28, s21, 1
    s_lshl_b32 s28, s28, 10
    s_and_b32 s29, s21, 1
    s_lshl_b32 s29, s29, 9
    s_add_u32 s28, s28, s29
    s_add_u32 s28, s28, 159744
    v_add_u32 v32, s28, v32
    v_and_b32 v33, 2, v30
    v_cmp_ne_u32 vcc, 0, v33
    s_nop 1
    s_mov_b64 s[50:51], vcc
    v_lshlrev_b32 v33, 3, v30
    v_add_u32 v33, 162816, v33
    s_nop 0
    v_cndmask_b32 v2, v33, v32, vcc
    v_and_b32 v33, 8, v30
    v_cmp_eq_u32 s[48:49], 0, v33
    v_bfe_u32 v32, v30, 2, 2
    s_lshl_b32 s28, s21, 3
    v_add_u32 v32, s28, v32
    v_add_u32 v34, s22, v32
    v_and_b32 v34, 31, v34
    v_lshlrev_b32 v34, 8, v34
    v_lshlrev_b32 v32, 13, v32
    v_add_u32 v32, v32, v34
    v_lshrrev_b32 v33, 4, v30
    v_lshlrev_b32 v33, 6, v33
    v_add_u32 v32, v32, v33
    v_and_b32 v33, 3, v30
    v_lshlrev_b32 v33, 4, v33
    v_add_u32 v3, v32, v33
    v_and_b32 v34, 1, v30
    v_cmp_eq_u32 vcc, 0, v34
    v_mov_b32 v32, 0xEEEEEEEE
    v_mov_b32 v33, 0x44444444
    v_cndmask_b32 v4, v32, v33, vcc
    s_mov_b32 s52, 0x3e0293ee
    v_and_b32 v32, 1, v30
    v_lshlrev_b32 v32, 4, v32
    v_mov_b32 v33, 0x3f80
    v_lshlrev_b32 v33, v32, v33
    v_bfe_u32 v32, v30, 1, 2
    v_cmp_eq_u32 vcc, 0, v32
    s_nop 1
    v_cndmask_b32 v12, 0, v33, vcc
    v_cmp_eq_u32 vcc, 1, v32
    s_nop 1
    v_cndmask_b32 v13, 0, v33, vcc
    v_cmp_eq_u32 vcc, 2, v32
    s_nop 1
    v_cndmask_b32 v14, 0, v33, vcc
    v_cmp_eq_u32 vcc, 3, v32
    s_nop 1
    v_cndmask_b32 v15, 0, v33, vcc
    v_add_u32 v32, 161792, v0
    ds_write_b128 v32, v[12:15]
    s_waitcnt lgkmcnt(0)
    s_mul_i32 s34, s21, 28672
    s_lshl_b32 s36, s21, 20
    v_lshrrev_b32 v32, 2, v30
    v_lshlrev_b32 v33, 13, v32
    v_lshrrev_b32 v34, 5, v30
    v_lshlrev_b32 v34, 1, v34
    v_and_b32 v35, 3, v30
    v_xor_b32 v35, v35, v34
    v_lshlrev_b32 v35, 4, v35
    v_add_u32 v33, v33, v35
    s_lshl_b32 s29, s21, 6
    s_add_u32 s28, s98, s29
    v_add_u32 v40, s28, v33
    v_lshrrev_b32 v32, 4, v30
    v_lshlrev_b32 v33, 10, v32
    s_lshl_b32 s28, s21, 8
    v_add_u32 v33, s28, v33
    v_and_b32 v34, 1, v32
    v_lshrrev_b32 v36, 1, v32
    v_lshlrev_b32 v36, 3, v36
    v_add_u32 v34, v34, v36
    v_and_b32 v35, 15, v30
    v_xor_b32 v35, v35, v34
    v_lshlrev_b32 v35, 4, v35
    v_add_u32 v41, v33, v35
    v_lshrrev_b32 v32, 5, v30
    v_lshlrev_b32 v32, 10, v32
    v_bfe_u32 v33, v30, 4, 1
    v_lshlrev_b32 v34, 9, v33
    v_add_u32 v32, v32, v34
    v_bfe_u32 v34, v30, 2, 2
    v_lshlrev_b32 v34, 6, v34
    v_add_u32 v32, v32, v34
    v_and_b32 v34, 3, v30
    v_lshlrev_b32 v34, 3, v34
    v_add_u32 v32, v32, v34
    v_add_u32 v32, s34, v32
    v_lshlrev_b32 v34, 5, v33
    v_add_u32 v43, v32, v34
    v_xor_b32 v34, 32, v34
    v_add_u32 v44, v32, v34
    v_lshrrev_b32 v32, 4, v30
    v_lshlrev_b32 v32, 10, v32
    v_bfe_u32 v34, v30, 2, 2
    v_lshlrev_b32 v35, 8, v34
    v_add_u32 v32, v32, v35
    v_and_b32 v35, 3, v30
    v_lshlrev_b32 v35, 5, v35
    v_add_u32 v32, v32, v35
    v_add_u32 v32, s34, v32
    v_bfe_u32 v33, v30, 3, 1
    v_lshlrev_b32 v33, 7, v33
    v_bfe_u32 v34, v30, 2, 1
    v_lshlrev_b32 v34, 4, v34
    v_xor_b32 v35, 0, v33
    v_xor_b32 v36, 0, v34
    v_add_u32 v35, v35, v36
    v_add_u32 v45, v32, v35
    v_xor_b32 v35, 0, v33
    v_xor_b32 v36, 16, v34
    v_add_u32 v35, v35, v36
    v_add_u32 v46, v32, v35
    v_xor_b32 v35, 128, v33
    v_xor_b32 v36, 0, v34
    v_add_u32 v35, v35, v36
    v_add_u32 v47, v32, v35
    v_xor_b32 v35, 128, v33
    v_xor_b32 v36, 16, v34
    v_add_u32 v35, v35, v36
    v_add_u32 v48, v32, v35
    v_lshlrev_b32 v32, 4, v30
    v_add_u32 v53, s34, v32
    s_lshl_b32 s35, s22, 17
    s_mov_b32 s8, s56
    s_mov_b32 s9, s57
    s_mov_b32 s10, 0x400000
    s_mov_b32 s11, 0x20000
    s_add_u32 m0, s34, 0
    s_xor_b32 s28, s36, 0
    s_add_u32 s28, s28, 0
    buffer_load_dwordx4 v40, s[8:11], s28 offen lds
    s_add_u32 m0, s34, 1024
    s_xor_b32 s28, s36, 0
    s_add_u32 s28, s28, 131072
    buffer_load_dwordx4 v40, s[8:11], s28 offen lds
    s_add_u32 m0, s34, 2048
    s_xor_b32 s28, s36, 0
    s_add_u32 s28, s28, 262144
    buffer_load_dwordx4 v40, s[8:11], s28 offen lds
    s_add_u32 m0, s34, 3072
    s_xor_b32 s28, s36, 0
    s_add_u32 s28, s28, 393216
    buffer_load_dwordx4 v40, s[8:11], s28 offen lds
    s_add_u32 m0, s34, 4096
    s_xor_b32 s28, s36, 524288
    s_add_u32 s28, s28, 0
    buffer_load_dwordx4 v40, s[8:11], s28 offen lds
    s_add_u32 m0, s34, 5120
    s_xor_b32 s28, s36, 524288
    s_add_u32 s28, s28, 131072
    buffer_load_dwordx4 v40, s[8:11], s28 offen lds
    s_add_u32 m0, s34, 6144
    s_xor_b32 s28, s36, 524288
    s_add_u32 s28, s28, 262144
    buffer_load_dwordx4 v40, s[8:11], s28 offen lds
    s_add_u32 m0, s34, 7168
    s_xor_b32 s28, s36, 524288
    s_add_u32 s28, s28, 393216
    buffer_load_dwordx4 v40, s[8:11], s28 offen lds
    s_add_u32 m0, s34, 8192
    s_xor_b32 s28, s36, 1048576
    s_add_u32 s28, s28, 0
    buffer_load_dwordx4 v40, s[8:11], s28 offen lds
    s_add_u32 m0, s34, 9216
    s_xor_b32 s28, s36, 1048576
    s_add_u32 s28, s28, 131072
    buffer_load_dwordx4 v40, s[8:11], s28 offen lds
    s_add_u32 m0, s34, 10240
    s_xor_b32 s28, s36, 1048576
    s_add_u32 s28, s28, 262144
    buffer_load_dwordx4 v40, s[8:11], s28 offen lds
    s_add_u32 m0, s34, 11264
    s_xor_b32 s28, s36, 1048576
    s_add_u32 s28, s28, 393216
    buffer_load_dwordx4 v40, s[8:11], s28 offen lds
    s_add_u32 m0, s34, 12288
    s_xor_b32 s28, s36, 1572864
    s_add_u32 s28, s28, 0
    buffer_load_dwordx4 v40, s[8:11], s28 offen lds
    s_add_u32 m0, s34, 13312
    s_xor_b32 s28, s36, 1572864
    s_add_u32 s28, s28, 131072
    buffer_load_dwordx4 v40, s[8:11], s28 offen lds
    s_add_u32 m0, s34, 14336
    s_xor_b32 s28, s36, 1572864
    s_add_u32 s28, s28, 262144
    buffer_load_dwordx4 v40, s[8:11], s28 offen lds
    s_add_u32 m0, s34, 15360
    s_xor_b32 s28, s36, 1572864
    s_add_u32 s28, s28, 393216
    buffer_load_dwordx4 v40, s[8:11], s28 offen lds
    s_add_u32 m0, s34, 16384
    s_xor_b32 s28, s36, 2097152
    s_add_u32 s28, s28, 0
    buffer_load_dwordx4 v40, s[8:11], s28 offen lds
    s_add_u32 m0, s34, 17408
    s_xor_b32 s28, s36, 2097152
    s_add_u32 s28, s28, 131072
    buffer_load_dwordx4 v40, s[8:11], s28 offen lds
    s_add_u32 m0, s34, 18432
    s_xor_b32 s28, s36, 2097152
    s_add_u32 s28, s28, 262144
    buffer_load_dwordx4 v40, s[8:11], s28 offen lds
    s_add_u32 m0, s34, 19456
    s_xor_b32 s28, s36, 2097152
    s_add_u32 s28, s28, 393216
    buffer_load_dwordx4 v40, s[8:11], s28 offen lds
    s_add_u32 m0, s34, 20480
    s_xor_b32 s28, s36, 2621440
    s_add_u32 s28, s28, 0
    buffer_load_dwordx4 v40, s[8:11], s28 offen lds
    s_add_u32 m0, s34, 21504
    s_xor_b32 s28, s36, 2621440
    s_add_u32 s28, s28, 131072
    buffer_load_dwordx4 v40, s[8:11], s28 offen lds
    s_add_u32 m0, s34, 22528
    s_xor_b32 s28, s36, 2621440
    s_add_u32 s28, s28, 262144
    buffer_load_dwordx4 v40, s[8:11], s28 offen lds
    s_add_u32 m0, s34, 23552
    s_xor_b32 s28, s36, 2621440
    s_add_u32 s28, s28, 393216
    buffer_load_dwordx4 v40, s[8:11], s28 offen lds
    s_add_u32 m0, s34, 24576
    s_xor_b32 s28, s36, 3145728
    s_add_u32 s28, s28, 0
    buffer_load_dwordx4 v40, s[8:11], s28 offen lds
    s_add_u32 m0, s34, 25600
    s_xor_b32 s28, s36, 3145728
    s_add_u32 s28, s28, 131072
    buffer_load_dwordx4 v40, s[8:11], s28 offen lds
    s_add_u32 m0, s34, 26624
    s_xor_b32 s28, s36, 3145728
    s_add_u32 s28, s28, 262144
    buffer_load_dwordx4 v40, s[8:11], s28 offen lds
    s_add_u32 m0, s34, 27648
    s_xor_b32 s28, s36, 3145728
    s_add_u32 s28, s28, 393216
    buffer_load_dwordx4 v40, s[8:11], s28 offen lds
    v_lshrrev_b32 v60, 2, v0
    v_and_b32 v60, 0xc0, v60
    v_lshlrev_b32 v34, 1, v0
    v_and_b32 v34, 32, v34
    v_add_u32 v60, v60, v34
    v_lshrrev_b32 v34, 3, v0
    v_and_b32 v34, 28, v34
    v_add_u32 v60, v60, v34
    s_cmp_lg_u32 s21, 0
    s_cbranch_scc1 L_noinit
    s_load_dwordx2 s[30:31], s[0:1], 56
    v_lshrrev_b32 v32, 4, v30
    v_lshlrev_b32 v32, 11, v32
    v_and_b32 v33, 1, v30
    v_lshlrev_b32 v33, 10, v33
    v_add_u32 v32, v32, v33
    v_bfe_u32 v33, v30, 1, 2
    v_lshlrev_b32 v33, 3, v33
    v_add_u32 v32, v32, v33
    v_bfe_u32 v33, v30, 3, 1
    v_lshlrev_b32 v33, 2, v33
    v_add_u32 v32, v32, v33
    s_lshl_b32 s29, s22, 5
    v_add_u32 v32, s29, v32
    s_waitcnt lgkmcnt(0)
    global_load_dword v61, v32, s[30:31]
    v_mov_b32 v12, -1
    v_mov_b32 v13, -1
    v_mov_b32 v14, -1
    v_mov_b32 v15, -1
    s_add_u32 s29, s97, 46137344
    buffer_store_dwordx4 v[12:15], v0, s[4:7], s29 offen offset:0
    buffer_store_dwordx4 v[12:15], v0, s[4:7], s29 offen offset:1024
    buffer_store_dwordx4 v[12:15], v0, s[4:7], s29 offen offset:2048
    buffer_store_dwordx4 v[12:15], v0, s[4:7], s29 offen offset:3072
    s_add_u32 s29, s97, 46141440
    buffer_store_dwordx4 v[12:15], v0, s[4:7], s29 offen offset:0
    buffer_store_dwordx4 v[12:15], v0, s[4:7], s29 offen offset:1024
    buffer_store_dwordx4 v[12:15], v0, s[4:7], s29 offen offset:2048
    buffer_store_dwordx4 v[12:15], v0, s[4:7], s29 offen offset:3072
    s_add_u32 s29, s97, 46399488
    buffer_store_dwordx4 v[12:15], v0, s[4:7], s29 offen offset:0
    buffer_store_dwordx4 v[12:15], v0, s[4:7], s29 offen offset:1024
    buffer_store_dwordx4 v[12:15], v0, s[4:7], s29 offen offset:2048
    buffer_store_dwordx4 v[12:15], v0, s[4:7], s29 offen offset:3072
    s_add_u32 s29, s97, 46403584
    buffer_store_dwordx4 v[12:15], v0, s[4:7], s29 offen offset:0
    buffer_store_dwordx4 v[12:15], v0, s[4:7], s29 offen offset:1024
    buffer_store_dwordx4 v[12:15], v0, s[4:7], s29 offen offset:2048
    buffer_store_dwordx4 v[12:15], v0, s[4:7], s29 offen offset:3072
    s_add_u32 s29, s98, 46931968
    buffer_store_dword v12, v60, s[4:7], s29 offen
    s_add_u32 s29, s98, 46940160
    buffer_store_dword v12, v60, s[4:7], s29 offen
    v_lshlrev_b32 v32, 12, v30
    v_mov_b32 v33, 0
    s_lshl_b32 s29, s22, 7
    s_add_u32 s29, s29, 47005696
    s_mov_b64 exec, 0xff
    buffer_store_dword v33, v32, s[4:7], s29 offen sc0 sc1
    s_mov_b64 exec, 1
    s_lshl_b32 s29, s22, 7
    s_add_u32 s29, s29, 46997504
    buffer_store_dword v33, v32, s[4:7], s29 offen sc0 sc1
    s_mov_b64 exec, s[26:27]
L_noinit:
    s_waitcnt vmcnt(24)
    ds_read_b64_tr_b16 a[0:1], v43 offset:0
    ds_read_b64_tr_b16 a[2:3], v43 offset:256
    ds_read_b64_tr_b16 a[4:5], v43 offset:2048
    ds_read_b64_tr_b16 a[6:7], v43 offset:2304
    ds_read_b64_tr_b16 a[64:65], v44 offset:0
    ds_read_b64_tr_b16 a[66:67], v44 offset:256
    ds_read_b64_tr_b16 a[68:69], v44 offset:2048
    ds_read_b64_tr_b16 a[70:71], v44 offset:2304
    s_waitcnt lgkmcnt(0)
    s_add_u32 m0, s34, 0
    s_xor_b32 s28, s36, 3670016
    s_add_u32 s28, s28, 0
    buffer_load_dwordx4 v40, s[8:11], s28 offen lds
    s_add_u32 m0, s34, 1024
    s_xor_b32 s28, s36, 3670016
    s_add_u32 s28, s28, 131072
    buffer_load_dwordx4 v40, s[8:11], s28 offen lds
    s_add_u32 m0, s34, 2048
    s_xor_b32 s28, s36, 3670016
    s_add_u32 s28, s28, 262144
    buffer_load_dwordx4 v40, s[8:11], s28 offen lds
    s_add_u32 m0, s34, 3072
    s_xor_b32 s28, s36, 3670016
    s_add_u32 s28, s28, 393216
    buffer_load_dwordx4 v40, s[8:11], s28 offen lds
    s_waitcnt vmcnt(24)
    ds_read_b64_tr_b16 a[8:9], v43 offset:4096
    ds_read_b64_tr_b16 a[10:11], v43 offset:4352
    ds_read_b64_tr_b16 a[12:13], v43 offset:6144
    ds_read_b64_tr_b16 a[14:15], v43 offset:6400
    ds_read_b64_tr_b16 a[72:73], v44 offset:4096
    ds_read_b64_tr_b16 a[74:75], v44 offset:4352
    ds_read_b64_tr_b16 a[76:77], v44 offset:6144
    ds_read_b64_tr_b16 a[78:79], v44 offset:6400
    s_waitcnt lgkmcnt(0)
    s_mov_b32 s8, s58
    s_mov_b32 s9, s59
    s_mov_b32 s10, 0x400000
    s_mov_b32 s11, 0x20000
    s_add_u32 m0, s34, 4096
    s_xor_b32 s28, s36, 0
    s_add_u32 s28, s28, 0
    buffer_load_dwordx4 v40, s[8:11], s28 offen lds
    s_add_u32 m0, s34, 5120
    s_xor_b32 s28, s36, 0
    s_add_u32 s28, s28, 131072
    buffer_load_dwordx4 v40, s[8:11], s28 offen lds
    s_add_u32 m0, s34, 6144
    s_xor_b32 s28, s36, 0
    s_add_u32 s28, s28, 262144
    buffer_load_dwordx4 v40, s[8:11], s28 offen lds
    s_add_u32 m0, s34, 7168
    s_xor_b32 s28, s36, 0
    s_add_u32 s28, s28, 393216
    buffer_load_dwordx4 v40, s[8:11], s28 offen lds
    s_waitcnt vmcnt(24)
    ds_read_b64_tr_b16 a[16:17], v43 offset:8192
    ds_read_b64_tr_b16 a[18:19], v43 offset:8448
    ds_read_b64_tr_b16 a[20:21], v43 offset:10240
    ds_read_b64_tr_b16 a[22:23], v43 offset:10496
    ds_read_b64_tr_b16 a[80:81], v44 offset:8192
    ds_read_b64_tr_b16 a[82:83], v44 offset:8448
    ds_read_b64_tr_b16 a[84:85], v44 offset:10240
    ds_read_b64_tr_b16 a[86:87], v44 offset:10496
    s_waitcnt lgkmcnt(0)
    s_add_u32 m0, s34, 8192
    s_xor_b32 s28, s36, 524288
    s_add_u32 s28, s28, 0
    buffer_load_dwordx4 v40, s[8:11], s28 offen lds
    s_add_u32 m0, s34, 9216
    s_xor_b32 s28, s36, 524288
    s_add_u32 s28, s28, 131072
    buffer_load_dwordx4 v40, s[8:11], s28 offen lds
    s_add_u32 m0, s34, 10240
    s_xor_b32 s28, s36, 524288
    s_add_u32 s28, s28, 262144
    buffer_load_dwordx4 v40, s[8:11], s28 offen lds
    s_add_u32 m0, s34, 11264
    s_xor_b32 s28, s36, 524288
    s_add_u32 s28, s28, 393216
    buffer_load_dwordx4 v40, s[8:11], s28 offen lds
    s_waitcnt vmcnt(24)
    ds_read_b64_tr_b16 a[24:25], v43 offset:12288
    ds_read_b64_tr_b16 a[26:27], v43 offset:12544
    ds_read_b64_tr_b16 a[28:29], v43 offset:14336
    ds_read_b64_tr_b16 a[30:31], v43 offset:14592
    ds_read_b64_tr_b16 a[88:89], v44 offset:12288
    ds_read_b64_tr_b16 a[90:91], v44 offset:12544
    ds_read_b64_tr_b16 a[92:93], v44 offset:14336
    ds_read_b64_tr_b16 a[94:95], v44 offset:14592
    s_waitcnt lgkmcnt(0)
    s_add_u32 m0, s34, 12288
    s_xor_b32 s28, s36, 1048576
    s_add_u32 s28, s28, 0
    buffer_load_dwordx4 v40, s[8:11], s28 offen lds
    s_add_u32 m0, s34, 13312
    s_xor_b32 s28, s36, 1048576
    s_add_u32 s28, s28, 131072
    buffer_load_dwordx4 v40, s[8:11], s28 offen lds
    s_add_u32 m0, s34, 14336
    s_xor_b32 s28, s36, 1048576
    s_add_u32 s28, s28, 262144
    buffer_load_dwordx4 v40, s[8:11], s28 offen lds
    s_add_u32 m0, s34, 15360
    s_xor_b32 s28, s36, 1048576
    s_add_u32 s28, s28, 393216
    buffer_load_dwordx4 v40, s[8:11], s28 offen lds
    s_waitcnt vmcnt(24)
    ds_read_b64_tr_b16 a[32:33], v43 offset:16384
    ds_read_b64_tr_b16 a[34:35], v43 offset:16640
    ds_read_b64_tr_b16 a[36:37], v43 offset:18432
    ds_read_b64_tr_b16 a[38:39], v43 offset:18688
    ds_read_b64_tr_b16 a[96:97], v44 offset:16384
    ds_read_b64_tr_b16 a[98:99], v44 offset:16640
    ds_read_b64_tr_b16 a[100:101], v44 offset:18432
    ds_read_b64_tr_b16 a[102:103], v44 offset:18688
    s_waitcnt lgkmcnt(0)
    s_add_u32 m0, s34, 16384
    s_xor_b32 s28, s36, 1572864
    s_add_u32 s28, s28, 0
    buffer_load_dwordx4 v40, s[8:11], s28 offen lds
    s_add_u32 m0, s34, 17408
    s_xor_b32 s28, s36, 1572864
    s_add_u32 s28, s28, 131072
    buffer_load_dwordx4 v40, s[8:11], s28 offen lds
    s_add_u32 m0, s34, 18432
    s_xor_b32 s28, s36, 1572864
    s_add_u32 s28, s28, 262144
    buffer_load_dwordx4 v40, s[8:11], s28 offen lds
    s_add_u32 m0, s34, 19456
    s_xor_b32 s28, s36, 1572864
    s_add_u32 s28, s28, 393216
    buffer_load_dwordx4 v40, s[8:11], s28 offen lds
    s_waitcnt vmcnt(24)
    ds_read_b64_tr_b16 a[40:41], v43 offset:20480
    ds_read_b64_tr_b16 a[42:43], v43 offset:20736
    ds_read_b64_tr_b16 a[44:45], v43 offset:22528
    ds_read_b64_tr_b16 a[46:47], v43 offset:22784
    ds_read_b64_tr_b16 a[104:105], v44 offset:20480
    ds_read_b64_tr_b16 a[106:107], v44 offset:20736
    ds_read_b64_tr_b16 a[108:109], v44 offset:22528
    ds_read_b64_tr_b16 a[110:111], v44 offset:22784
    s_waitcnt lgkmcnt(0)
    s_add_u32 m0, s34, 20480
    s_xor_b32 s28, s36, 2097152
    s_add_u32 s28, s28, 0
    buffer_load_dwordx4 v40, s[8:11], s28 offen lds
    s_add_u32 m0, s34, 21504
    s_xor_b32 s28, s36, 2097152
    s_add_u32 s28, s28, 131072
    buffer_load_dwordx4 v40, s[8:11], s28 offen lds
    s_add_u32 m0, s34, 22528
    s_xor_b32 s28, s36, 2097152
    s_add_u32 s28, s28, 262144
    buffer_load_dwordx4 v40, s[8:11], s28 offen lds
    s_add_u32 m0, s34, 23552
    s_xor_b32 s28, s36, 2097152
    s_add_u32 s28, s28, 393216
    buffer_load_dwordx4 v40, s[8:11], s28 offen lds
    s_waitcnt vmcnt(24)
    ds_read_b64_tr_b16 a[48:49], v43 offset:24576
    ds_read_b64_tr_b16 a[50:51], v43 offset:24832
    ds_read_b64_tr_b16 a[52:53], v43 offset:26624
    ds_read_b64_tr_b16 a[54:55], v43 offset:26880
    ds_read_b64_tr_b16 a[112:113], v44 offset:24576
    ds_read_b64_tr_b16 a[114:115], v44 offset:24832
    ds_read_b64_tr_b16 a[116:117], v44 offset:26624
    ds_read_b64_tr_b16 a[118:119], v44 offset:26880
    s_waitcnt lgkmcnt(0)
    s_add_u32 m0, s34, 24576
    s_xor_b32 s28, s36, 2621440
    s_add_u32 s28, s28, 0
    buffer_load_dwordx4 v40, s[8:11], s28 offen lds
    s_add_u32 m0, s34, 25600
    s_xor_b32 s28, s36, 2621440
    s_add_u32 s28, s28, 131072
    buffer_load_dwordx4 v40, s[8:11], s28 offen lds
    s_add_u32 m0, s34, 26624
    s_xor_b32 s28, s36, 2621440
    s_add_u32 s28, s28, 262144
    buffer_load_dwordx4 v40, s[8:11], s28 offen lds
    s_add_u32 m0, s34, 27648
    s_xor_b32 s28, s36, 2621440
    s_add_u32 s28, s28, 393216
    buffer_load_dwordx4 v40, s[8:11], s28 offen lds
    s_waitcnt vmcnt(24)
    ds_read_b64_tr_b16 a[56:57], v43 offset:0
    ds_read_b64_tr_b16 a[58:59], v43 offset:256
    ds_read_b64_tr_b16 a[60:61], v43 offset:2048
    ds_read_b64_tr_b16 a[62:63], v43 offset:2304
    ds_read_b64_tr_b16 a[120:121], v44 offset:0
    ds_read_b64_tr_b16 a[122:123], v44 offset:256
    ds_read_b64_tr_b16 a[124:125], v44 offset:2048
    ds_read_b64_tr_b16 a[126:127], v44 offset:2304
    s_waitcnt lgkmcnt(0)
    s_cmp_lg_u32 s21, 0
    s_cbranch_scc1 L_hk_1
    s_add_u32 s29, s98, 46923776
    buffer_store_dword v61, v60, s[4:7], s29 offen
    s_mov_b64 exec, 1
    v_mov_b32 v62, 24
    v_mov_b32 v63, 1
    global_atomic_add v62, v63, s[24:25] sc1
    s_mov_b64 exec, s[26:27]
L_hk_1:
    s_add_u32 m0, s34, 0
    s_xor_b32 s28, s36, 3145728
    s_add_u32 s28, s28, 0
    buffer_load_dwordx4 v40, s[8:11], s28 offen lds
    s_add_u32 m0, s34, 1024
    s_xor_b32 s28, s36, 3145728
    s_add_u32 s28, s28, 131072
    buffer_load_dwordx4 v40, s[8:11], s28 offen lds
    s_add_u32 m0, s34, 2048
    s_xor_b32 s28, s36, 3145728
    s_add_u32 s28, s28, 262144
    buffer_load_dwordx4 v40, s[8:11], s28 offen lds
    s_add_u32 m0, s34, 3072
    s_xor_b32 s28, s36, 3145728
    s_add_u32 s28, s28, 393216
    buffer_load_dwordx4 v40, s[8:11], s28 offen lds
    s_waitcnt vmcnt(24)
    ds_read_b64_tr_b16 a[128:129], v43 offset:4096
    ds_read_b64_tr_b16 a[130:131], v43 offset:4352
    ds_read_b64_tr_b16 a[132:133], v43 offset:6144
    ds_read_b64_tr_b16 a[134:135], v43 offset:6400
    ds_read_b64_tr_b16 a[192:193], v44 offset:4096
    ds_read_b64_tr_b16 a[194:195], v44 offset:4352
    ds_read_b64_tr_b16 a[196:197], v44 offset:6144
    ds_read_b64_tr_b16 a[198:199], v44 offset:6400
    s_waitcnt lgkmcnt(0)
    s_add_u32 m0, s34, 4096
    s_xor_b32 s28, s36, 3670016
    s_add_u32 s28, s28, 0
    buffer_load_dwordx4 v40, s[8:11], s28 offen lds
    s_add_u32 m0, s34, 5120
    s_xor_b32 s28, s36, 3670016
    s_add_u32 s28, s28, 131072
    buffer_load_dwordx4 v40, s[8:11], s28 offen lds
    s_add_u32 m0, s34, 6144
    s_xor_b32 s28, s36, 3670016
    s_add_u32 s28, s28, 262144
    buffer_load_dwordx4 v40, s[8:11], s28 offen lds
    s_add_u32 m0, s34, 7168
    s_xor_b32 s28, s36, 3670016
    s_add_u32 s28, s28, 393216
    buffer_load_dwordx4 v40, s[8:11], s28 offen lds
    s_waitcnt vmcnt(24)
    ds_read_b64_tr_b16 a[136:137], v43 offset:8192
    ds_read_b64_tr_b16 a[138:139], v43 offset:8448
    ds_read_b64_tr_b16 a[140:141], v43 offset:10240
    ds_read_b64_tr_b16 a[142:143], v43 offset:10496
    ds_read_b64_tr_b16 a[200:201], v44 offset:8192
    ds_read_b64_tr_b16 a[202:203], v44 offset:8448
    ds_read_b64_tr_b16 a[204:205], v44 offset:10240
    ds_read_b64_tr_b16 a[206:207], v44 offset:10496
    s_waitcnt lgkmcnt(0)
    s_mov_b32 s8, s62
    s_mov_b32 s9, s63
    s_mov_b32 s10, 0x400000
    s_mov_b32 s11, 0x20000
    s_add_u32 m0, s34, 8192
    s_add_u32 s28, s35, 0
    buffer_load_dwordx4 v41, s[8:11], s28 offen lds
    s_add_u32 m0, s34, 9216
    s_add_u32 s28, s35, 4096
    buffer_load_dwordx4 v41, s[8:11], s28 offen lds
    s_add_u32 m0, s34, 10240
    s_add_u32 s28, s35, 8192
    buffer_load_dwordx4 v41, s[8:11], s28 offen lds
    s_add_u32 m0, s34, 11264
    s_add_u32 s28, s35, 12288
    buffer_load_dwordx4 v41, s[8:11], s28 offen lds
    s_waitcnt vmcnt(24)
    ds_read_b64_tr_b16 a[144:145], v43 offset:12288
    ds_read_b64_tr_b16 a[146:147], v43 offset:12544
    ds_read_b64_tr_b16 a[148:149], v43 offset:14336
    ds_read_b64_tr_b16 a[150:151], v43 offset:14592
    ds_read_b64_tr_b16 a[208:209], v44 offset:12288
    ds_read_b64_tr_b16 a[210:211], v44 offset:12544
    ds_read_b64_tr_b16 a[212:213], v44 offset:14336
    ds_read_b64_tr_b16 a[214:215], v44 offset:14592
    s_waitcnt lgkmcnt(0)
    s_add_u32 m0, s34, 12288
    s_add_u32 s28, s35, 16384
    buffer_load_dwordx4 v41, s[8:11], s28 offen lds
    s_add_u32 m0, s34, 13312
    s_add_u32 s28, s35, 20480
    buffer_load_dwordx4 v41, s[8:11], s28 offen lds
    s_add_u32 m0, s34, 14336
    s_add_u32 s28, s35, 24576
    buffer_load_dwordx4 v41, s[8:11], s28 offen lds
    s_add_u32 m0, s34, 15360
    s_add_u32 s28, s35, 28672
    buffer_load_dwordx4 v41, s[8:11], s28 offen lds
    s_waitcnt vmcnt(24)
    ds_read_b64_tr_b16 a[152:153], v43 offset:16384
    ds_read_b64_tr_b16 a[154:155], v43 offset:16640
    ds_read_b64_tr_b16 a[156:157], v43 offset:18432
    ds_read_b64_tr_b16 a[158:159], v43 offset:18688
    ds_read_b64_tr_b16 a[216:217], v44 offset:16384
    ds_read_b64_tr_b16 a[218:219], v44 offset:16640
    ds_read_b64_tr_b16 a[220:221], v44 offset:18432
    ds_read_b64_tr_b16 a[222:223], v44 offset:18688
    s_waitcnt lgkmcnt(0)
    s_add_u32 m0, s34, 16384
    s_add_u32 s28, s35, 32768
    buffer_load_dwordx4 v41, s[8:11], s28 offen lds
    s_add_u32 m0, s34, 17408
    s_add_u32 s28, s35, 36864
    buffer_load_dwordx4 v41, s[8:11], s28 offen lds
    s_add_u32 m0, s34, 18432
    s_add_u32 s28, s35, 40960
    buffer_load_dwordx4 v41, s[8:11], s28 offen lds
    s_add_u32 m0, s34, 19456
    s_add_u32 s28, s35, 45056
    buffer_load_dwordx4 v41, s[8:11], s28 offen lds
    s_waitcnt vmcnt(24)
    ds_read_b64_tr_b16 a[160:161], v43 offset:20480
    ds_read_b64_tr_b16 a[162:163], v43 offset:20736
    ds_read_b64_tr_b16 a[164:165], v43 offset:22528
    ds_read_b64_tr_b16 a[166:167], v43 offset:22784
    ds_read_b64_tr_b16 a[224:225], v44 offset:20480
    ds_read_b64_tr_b16 a[226:227], v44 offset:20736
    ds_read_b64_tr_b16 a[228:229], v44 offset:22528
    ds_read_b64_tr_b16 a[230:231], v44 offset:22784
    s_waitcnt lgkmcnt(0)
    s_add_u32 m0, s34, 20480
    s_add_u32 s28, s35, 49152
    buffer_load_dwordx4 v41, s[8:11], s28 offen lds
    s_add_u32 m0, s34, 21504
    s_add_u32 s28, s35, 53248
    buffer_load_dwordx4 v41, s[8:11], s28 offen lds
    s_add_u32 m0, s34, 22528
    s_add_u32 s28, s35, 57344
    buffer_load_dwordx4 v41, s[8:11], s28 offen lds
    s_add_u32 m0, s34, 23552
    s_add_u32 s28, s35, 61440
    buffer_load_dwordx4 v41, s[8:11], s28 offen lds
    s_waitcnt vmcnt(24)
    ds_read_b64_tr_b16 a[168:169], v43 offset:24576
    ds_read_b64_tr_b16 a[170:171], v43 offset:24832
    ds_read_b64_tr_b16 a[172:173], v43 offset:26624
    ds_read_b64_tr_b16 a[174:175], v43 offset:26880
    ds_read_b64_tr_b16 a[232:233], v44 offset:24576
    ds_read_b64_tr_b16 a[234:235], v44 offset:24832
    ds_read_b64_tr_b16 a[236:237], v44 offset:26624
    ds_read_b64_tr_b16 a[238:239], v44 offset:26880
    s_waitcnt lgkmcnt(0)
    s_add_u32 m0, s34, 24576
    s_add_u32 s28, s35, 65536
    buffer_load_dwordx4 v41, s[8:11], s28 offen lds
    s_add_u32 m0, s34, 25600
    s_add_u32 s28, s35, 69632
    buffer_load_dwordx4 v41, s[8:11], s28 offen lds
    s_add_u32 m0, s34, 26624
    s_add_u32 s28, s35, 73728
    buffer_load_dwordx4 v41, s[8:11], s28 offen lds
    s_add_u32 m0, s34, 27648
    s_add_u32 s28, s35, 77824
    buffer_load_dwordx4 v41, s[8:11], s28 offen lds
    s_waitcnt vmcnt(24)
    ds_read_b64_tr_b16 a[176:177], v43 offset:0
    ds_read_b64_tr_b16 a[178:179], v43 offset:256
    ds_read_b64_tr_b16 a[180:181], v43 offset:2048
    ds_read_b64_tr_b16 a[182:183], v43 offset:2304
    ds_read_b64_tr_b16 a[240:241], v44 offset:0
    ds_read_b64_tr_b16 a[242:243], v44 offset:256
    ds_read_b64_tr_b16 a[244:245], v44 offset:2048
    ds_read_b64_tr_b16 a[246:247], v44 offset:2304
    s_waitcnt lgkmcnt(0)
    s_cmp_lg_u32 s21, 0
    s_cbranch_scc1 L_hk_2
    s_mov_b64 exec, 1
    v_mov_b32 v62, 16
    v_mov_b32 v63, 1
    global_atomic_add v62, v63, s[24:25] sc1
    s_mov_b64 exec, s[26:27]
L_hk_2:
    s_add_u32 m0, s34, 0
    s_add_u32 s28, s35, 81920
    buffer_load_dwordx4 v41, s[8:11], s28 offen lds
    s_add_u32 m0, s34, 1024
    s_add_u32 s28, s35, 86016
    buffer_load_dwordx4 v41, s[8:11], s28 offen lds
    s_add_u32 m0, s34, 2048
    s_add_u32 s28, s35, 90112
    buffer_load_dwordx4 v41, s[8:11], s28 offen lds
    s_add_u32 m0, s34, 3072
    s_add_u32 s28, s35, 94208
    buffer_load_dwordx4 v41, s[8:11], s28 offen lds
    s_waitcnt vmcnt(24)
    ds_read_b64_tr_b16 a[184:185], v43 offset:4096
    ds_read_b64_tr_b16 a[186:187], v43 offset:4352
    ds_read_b64_tr_b16 a[188:189], v43 offset:6144
    ds_read_b64_tr_b16 a[190:191], v43 offset:6400
    ds_read_b64_tr_b16 a[248:249], v44 offset:4096
    ds_read_b64_tr_b16 a[250:251], v44 offset:4352
    ds_read_b64_tr_b16 a[252:253], v44 offset:6144
    ds_read_b64_tr_b16 a[254:255], v44 offset:6400
    s_waitcnt lgkmcnt(0)
    s_add_u32 m0, s34, 4096
    s_add_u32 s28, s35, 98304
    buffer_load_dwordx4 v41, s[8:11], s28 offen lds
    s_add_u32 m0, s34, 5120
    s_add_u32 s28, s35, 102400
    buffer_load_dwordx4 v41, s[8:11], s28 offen lds
    s_add_u32 m0, s34, 6144
    s_add_u32 s28, s35, 106496
    buffer_load_dwordx4 v41, s[8:11], s28 offen lds
    s_add_u32 m0, s34, 7168
    s_add_u32 s28, s35, 110592
    buffer_load_dwordx4 v41, s[8:11], s28 offen lds
    s_waitcnt vmcnt(24)
    ds_read_b64_tr_b16 v[128:129], v45 offset:8192
    ds_read_b64_tr_b16 v[144:145], v45 offset:8200
    ds_read_b64_tr_b16 v[160:161], v46 offset:8192
    ds_read_b64_tr_b16 v[176:177], v46 offset:8200
    ds_read_b64_tr_b16 v[192:193], v47 offset:8192
    ds_read_b64_tr_b16 v[208:209], v47 offset:8200
    ds_read_b64_tr_b16 v[224:225], v48 offset:8192
    ds_read_b64_tr_b16 v[240:241], v48 offset:8200
    s_waitcnt lgkmcnt(0)
    s_add_u32 m0, s34, 8192
    s_add_u32 s28, s35, 114688
    buffer_load_dwordx4 v41, s[8:11], s28 offen lds
    s_add_u32 m0, s34, 9216
    s_add_u32 s28, s35, 118784
    buffer_load_dwordx4 v41, s[8:11], s28 offen lds
    s_add_u32 m0, s34, 10240
    s_add_u32 s28, s35, 122880
    buffer_load_dwordx4 v41, s[8:11], s28 offen lds
    s_add_u32 m0, s34, 11264
    s_add_u32 s28, s35, 126976
    buffer_load_dwordx4 v41, s[8:11], s28 offen lds
    s_waitcnt vmcnt(24)
    ds_read_b64_tr_b16 v[130:131], v45 offset:12288
    ds_read_b64_tr_b16 v[146:147], v45 offset:12296
    ds_read_b64_tr_b16 v[162:163], v46 offset:12288
    ds_read_b64_tr_b16 v[178:179], v46 offset:12296
    ds_read_b64_tr_b16 v[194:195], v47 offset:12288
    ds_read_b64_tr_b16 v[210:211], v47 offset:12296
    ds_read_b64_tr_b16 v[226:227], v48 offset:12288
    ds_read_b64_tr_b16 v[242:243], v48 offset:12296
    s_waitcnt lgkmcnt(0)
    s_mov_b32 s8, s60
    s_mov_b32 s9, s61
    s_mov_b32 s10, 0x400000
    s_mov_b32 s11, 0x20000
    s_add_u32 m0, s34, 12288
    s_xor_b32 s28, s36, 0
    s_add_u32 s28, s28, 0
    buffer_load_dwordx4 v40, s[8:11], s28 offen lds
    s_add_u32 m0, s34, 13312
    s_xor_b32 s28, s36, 0
    s_add_u32 s28, s28, 131072
    buffer_load_dwordx4 v40, s[8:11], s28 offen lds
    s_add_u32 m0, s34, 14336
    s_xor_b32 s28, s36, 0
    s_add_u32 s28, s28, 262144
    buffer_load_dwordx4 v40, s[8:11], s28 offen lds
    s_add_u32 m0, s34, 15360
    s_xor_b32 s28, s36, 0
    s_add_u32 s28, s28, 393216
    buffer_load_dwordx4 v40, s[8:11], s28 offen lds
    s_waitcnt vmcnt(24)
    ds_read_b64_tr_b16 v[132:133], v45 offset:16384
    ds_read_b64_tr_b16 v[148:149], v45 offset:16392
    ds_read_b64_tr_b16 v[164:165], v46 offset:16384
    ds_read_b64_tr_b16 v[180:181], v46 offset:16392
    ds_read_b64_tr_b16 v[196:197], v47 offset:16384
    ds_read_b64_tr_b16 v[212:213], v47 offset:16392
    ds_read_b64_tr_b16 v[228:229], v48 offset:16384
    ds_read_b64_tr_b16 v[244:245], v48 offset:16392
    s_waitcnt lgkmcnt(0)
    s_add_u32 m0, s34, 16384
    s_xor_b32 s28, s36, 524288
    s_add_u32 s28, s28, 0
    buffer_load_dwordx4 v40, s[8:11], s28 offen lds
    s_add_u32 m0, s34, 17408
    s_xor_b32 s28, s36, 524288
    s_add_u32 s28, s28, 131072
    buffer_load_dwordx4 v40, s[8:11], s28 offen lds
    s_add_u32 m0, s34, 18432
    s_xor_b32 s28, s36, 524288
    s_add_u32 s28, s28, 262144
    buffer_load_dwordx4 v40, s[8:11], s28 offen lds
    s_add_u32 m0, s34, 19456
    s_xor_b32 s28, s36, 524288
    s_add_u32 s28, s28, 393216
    buffer_load_dwordx4 v40, s[8:11], s28 offen lds
    s_waitcnt vmcnt(24)
    ds_read_b64_tr_b16 v[134:135], v45 offset:20480
    ds_read_b64_tr_b16 v[150:151], v45 offset:20488
    ds_read_b64_tr_b16 v[166:167], v46 offset:20480
    ds_read_b64_tr_b16 v[182:183], v46 offset:20488
    ds_read_b64_tr_b16 v[198:199], v47 offset:20480
    ds_read_b64_tr_b16 v[214:215], v47 offset:20488
    ds_read_b64_tr_b16 v[230:231], v48 offset:20480
    ds_read_b64_tr_b16 v[246:247], v48 offset:20488
    s_waitcnt lgkmcnt(0)
    s_add_u32 m0, s34, 20480
    s_xor_b32 s28, s36, 1048576
    s_add_u32 s28, s28, 0
    buffer_load_dwordx4 v40, s[8:11], s28 offen lds
    s_add_u32 m0, s34, 21504
    s_xor_b32 s28, s36, 1048576
    s_add_u32 s28, s28, 131072
    buffer_load_dwordx4 v40, s[8:11], s28 offen lds
    s_add_u32 m0, s34, 22528
    s_xor_b32 s28, s36, 1048576
    s_add_u32 s28, s28, 262144
    buffer_load_dwordx4 v40, s[8:11], s28 offen lds
    s_add_u32 m0, s34, 23552
    s_xor_b32 s28, s36, 1048576
    s_add_u32 s28, s28, 393216
    buffer_load_dwordx4 v40, s[8:11], s28 offen lds
    s_waitcnt vmcnt(24)
    ds_read_b64_tr_b16 v[136:137], v45 offset:24576
    ds_read_b64_tr_b16 v[152:153], v45 offset:24584
    ds_read_b64_tr_b16 v[168:169], v46 offset:24576
    ds_read_b64_tr_b16 v[184:185], v46 offset:24584
    ds_read_b64_tr_b16 v[200:201], v47 offset:24576
    ds_read_b64_tr_b16 v[216:217], v47 offset:24584
    ds_read_b64_tr_b16 v[232:233], v48 offset:24576
    ds_read_b64_tr_b16 v[248:249], v48 offset:24584
    s_waitcnt lgkmcnt(0)
    s_add_u32 m0, s34, 24576
    s_xor_b32 s28, s36, 1572864
    s_add_u32 s28, s28, 0
    buffer_load_dwordx4 v40, s[8:11], s28 offen lds
    s_add_u32 m0, s34, 25600
    s_xor_b32 s28, s36, 1572864
    s_add_u32 s28, s28, 131072
    buffer_load_dwordx4 v40, s[8:11], s28 offen lds
    s_add_u32 m0, s34, 26624
    s_xor_b32 s28, s36, 1572864
    s_add_u32 s28, s28, 262144
    buffer_load_dwordx4 v40, s[8:11], s28 offen lds
    s_add_u32 m0, s34, 27648
    s_xor_b32 s28, s36, 1572864
    s_add_u32 s28, s28, 393216
    buffer_load_dwordx4 v40, s[8:11], s28 offen lds
    s_waitcnt vmcnt(24)
    ds_read_b64_tr_b16 v[138:139], v45 offset:0
    ds_read_b64_tr_b16 v[154:155], v45 offset:8
    ds_read_b64_tr_b16 v[170:171], v46 offset:0
    ds_read_b64_tr_b16 v[186:187], v46 offset:8
    ds_read_b64_tr_b16 v[202:203], v47 offset:0
    ds_read_b64_tr_b16 v[218:219], v47 offset:8
    ds_read_b64_tr_b16 v[234:235], v48 offset:0
    ds_read_b64_tr_b16 v[250:251], v48 offset:8
    s_waitcnt lgkmcnt(0)
    s_add_u32 m0, s34, 0
    s_xor_b32 s28, s36, 2097152
    s_add_u32 s28, s28, 0
    buffer_load_dwordx4 v40, s[8:11], s28 offen lds
    s_add_u32 m0, s34, 1024
    s_xor_b32 s28, s36, 2097152
    s_add_u32 s28, s28, 131072
    buffer_load_dwordx4 v40, s[8:11], s28 offen lds
    s_add_u32 m0, s34, 2048
    s_xor_b32 s28, s36, 2097152
    s_add_u32 s28, s28, 262144
    buffer_load_dwordx4 v40, s[8:11], s28 offen lds
    s_add_u32 m0, s34, 3072
    s_xor_b32 s28, s36, 2097152
    s_add_u32 s28, s28, 393216
    buffer_load_dwordx4 v40, s[8:11], s28 offen lds
    s_waitcnt vmcnt(24)
    ds_read_b64_tr_b16 v[140:141], v45 offset:4096
    ds_read_b64_tr_b16 v[156:157], v45 offset:4104
    ds_read_b64_tr_b16 v[172:173], v46 offset:4096
    ds_read_b64_tr_b16 v[188:189], v46 offset:4104
    ds_read_b64_tr_b16 v[204:205], v47 offset:4096
    ds_read_b64_tr_b16 v[220:221], v47 offset:4104
    ds_read_b64_tr_b16 v[236:237], v48 offset:4096
    ds_read_b64_tr_b16 v[252:253], v48 offset:4104
    s_waitcnt lgkmcnt(0)
    s_add_u32 m0, s34, 4096
    s_xor_b32 s28, s36, 2621440
    s_add_u32 s28, s28, 0
    buffer_load_dwordx4 v40, s[8:11], s28 offen lds
    s_add_u32 m0, s34, 5120
    s_xor_b32 s28, s36, 2621440
    s_add_u32 s28, s28, 131072
    buffer_load_dwordx4 v40, s[8:11], s28 offen lds
    s_add_u32 m0, s34, 6144
    s_xor_b32 s28, s36, 2621440
    s_add_u32 s28, s28, 262144
    buffer_load_dwordx4 v40, s[8:11], s28 offen lds
    s_add_u32 m0, s34, 7168
    s_xor_b32 s28, s36, 2621440
    s_add_u32 s28, s28, 393216
    buffer_load_dwordx4 v40, s[8:11], s28 offen lds
    s_waitcnt vmcnt(24)
    ds_read_b64_tr_b16 v[142:143], v45 offset:8192
    ds_read_b64_tr_b16 v[158:159], v45 offset:8200
    ds_read_b64_tr_b16 v[174:175], v46 offset:8192
    ds_read_b64_tr_b16 v[190:191], v46 offset:8200
    ds_read_b64_tr_b16 v[206:207], v47 offset:8192
    ds_read_b64_tr_b16 v[222:223], v47 offset:8200
    ds_read_b64_tr_b16 v[238:239], v48 offset:8192
    ds_read_b64_tr_b16 v[254:255], v48 offset:8200
    s_waitcnt lgkmcnt(0)
    s_add_u32 m0, s34, 8192
    s_xor_b32 s28, s36, 3145728
    s_add_u32 s28, s28, 0
    buffer_load_dwordx4 v40, s[8:11], s28 offen lds
    s_add_u32 m0, s34, 9216
    s_xor_b32 s28, s36, 3145728
    s_add_u32 s28, s28, 131072
    buffer_load_dwordx4 v40, s[8:11], s28 offen lds
    s_add_u32 m0, s34, 10240
    s_xor_b32 s28, s36, 3145728
    s_add_u32 s28, s28, 262144
    buffer_load_dwordx4 v40, s[8:11], s28 offen lds
    s_add_u32 m0, s34, 11264
    s_xor_b32 s28, s36, 3145728
    s_add_u32 s28, s28, 393216
    buffer_load_dwordx4 v40, s[8:11], s28 offen lds
    s_waitcnt vmcnt(24)
    ds_read_b64_tr_b16 v[112:113], v43 offset:12288
    ds_read_b64_tr_b16 v[114:115], v43 offset:12544
    ds_read_b64_tr_b16 v[116:117], v43 offset:14336
    ds_read_b64_tr_b16 v[118:119], v43 offset:14592
    ds_read_b64_tr_b16 v[120:121], v44 offset:12288
    ds_read_b64_tr_b16 v[122:123], v44 offset:12544
    ds_read_b64_tr_b16 v[124:125], v44 offset:14336
    ds_read_b64_tr_b16 v[126:127], v44 offset:14592
    s_waitcnt lgkmcnt(0)
    s_add_u32 m0, s34, 12288
    s_xor_b32 s28, s36, 3670016
    s_add_u32 s28, s28, 0
    buffer_load_dwordx4 v40, s[8:11], s28 offen lds
    s_add_u32 m0, s34, 13312
    s_xor_b32 s28, s36, 3670016
    s_add_u32 s28, s28, 131072
    buffer_load_dwordx4 v40, s[8:11], s28 offen lds
    s_add_u32 m0, s34, 14336
    s_xor_b32 s28, s36, 3670016
    s_add_u32 s28, s28, 262144
    buffer_load_dwordx4 v40, s[8:11], s28 offen lds
    s_add_u32 m0, s34, 15360
    s_xor_b32 s28, s36, 3670016
    s_add_u32 s28, s28, 393216
    buffer_load_dwordx4 v40, s[8:11], s28 offen lds
    s_waitcnt vmcnt(24)
    ds_read_b64_tr_b16 v[72:73], v43 offset:16384
    ds_read_b64_tr_b16 v[74:75], v43 offset:16640
    ds_read_b64_tr_b16 v[76:77], v43 offset:18432
    ds_read_b64_tr_b16 v[78:79], v43 offset:18688
    ds_read_b64_tr_b16 v[80:81], v44 offset:16384
    ds_read_b64_tr_b16 v[82:83], v44 offset:16640
    ds_read_b64_tr_b16 v[84:85], v44 offset:18432
    ds_read_b64_tr_b16 v[86:87], v44 offset:18688
    s_waitcnt lgkmcnt(0)
    ds_write_b128 v53, v[72:75] offset:16384
    ds_write_b128 v53, v[76:79] offset:17408
    ds_write_b128 v53, v[80:83] offset:18432
    ds_write_b128 v53, v[84:87] offset:19456
    s_waitcnt lgkmcnt(0)
    s_waitcnt vmcnt(20)
    ds_read_b64_tr_b16 v[72:73], v43 offset:20480
    ds_read_b64_tr_b16 v[74:75], v43 offset:20736
    ds_read_b64_tr_b16 v[76:77], v43 offset:22528
    ds_read_b64_tr_b16 v[78:79], v43 offset:22784
    ds_read_b64_tr_b16 v[80:81], v44 offset:20480
    ds_read_b64_tr_b16 v[82:83], v44 offset:20736
    ds_read_b64_tr_b16 v[84:85], v44 offset:22528
    ds_read_b64_tr_b16 v[86:87], v44 offset:22784
    s_waitcnt lgkmcnt(0)
    ds_write_b128 v53, v[72:75] offset:20480
    ds_write_b128 v53, v[76:79] offset:21504
    ds_write_b128 v53, v[80:83] offset:22528
    ds_write_b128 v53, v[84:87] offset:23552
    s_waitcnt lgkmcnt(0)
    s_waitcnt vmcnt(16)
    ds_read_b64_tr_b16 v[72:73], v43 offset:24576
    ds_read_b64_tr_b16 v[74:75], v43 offset:24832
    ds_read_b64_tr_b16 v[76:77], v43 offset:26624
    ds_read_b64_tr_b16 v[78:79], v43 offset:26880
    ds_read_b64_tr_b16 v[80:81], v44 offset:24576
    ds_read_b64_tr_b16 v[82:83], v44 offset:24832
    ds_read_b64_tr_b16 v[84:85], v44 offset:26624
    ds_read_b64_tr_b16 v[86:87], v44 offset:26880
    s_waitcnt lgkmcnt(0)
    ds_write_b128 v53, v[72:75] offset:24576
    ds_write_b128 v53, v[76:79] offset:25600
    ds_write_b128 v53, v[80:83] offset:26624
    ds_write_b128 v53, v[84:87] offset:27648
    s_waitcnt lgkmcnt(0)
    s_waitcnt vmcnt(12)
    ds_read_b64_tr_b16 v[72:73], v43 offset:0
    ds_read_b64_tr_b16 v[74:75], v43 offset:256
    ds_read_b64_tr_b16 v[76:77], v43 offset:2048
    ds_read_b64_tr_b16 v[78:79], v43 offset:2304
    ds_read_b64_tr_b16 v[80:81], v44 offset:0
    ds_read_b64_tr_b16 v[82:83], v44 offset:256
    ds_read_b64_tr_b16 v[84:85], v44 offset:2048
    ds_read_b64_tr_b16 v[86:87], v44 offset:2304
    s_waitcnt lgkmcnt(0)
    ds_write_b128 v53, v[72:75] offset:0
    ds_write_b128 v53, v[76:79] offset:1024
    ds_write_b128 v53, v[80:83] offset:2048
    ds_write_b128 v53, v[84:87] offset:3072
    s_waitcnt lgkmcnt(0)
    s_waitcnt vmcnt(8)
    ds_read_b64_tr_b16 v[72:73], v43 offset:4096
    ds_read_b64_tr_b16 v[74:75], v43 offset:4352
    ds_read_b64_tr_b16 v[76:77], v43 offset:6144
    ds_read_b64_tr_b16 v[78:79], v43 offset:6400
    ds_read_b64_tr_b16 v[80:81], v44 offset:4096
    ds_read_b64_tr_b16 v[82:83], v44 offset:4352
    ds_read_b64_tr_b16 v[84:85], v44 offset:6144
    ds_read_b64_tr_b16 v[86:87], v44 offset:6400
    s_waitcnt lgkmcnt(0)
    ds_write_b128 v53, v[72:75] offset:4096
    ds_write_b128 v53, v[76:79] offset:5120
    ds_write_b128 v53, v[80:83] offset:6144
    ds_write_b128 v53, v[84:87] offset:7168
    s_waitcnt lgkmcnt(0)
    s_waitcnt vmcnt(4)
    ds_read_b64_tr_b16 v[72:73], v43 offset:8192
    ds_read_b64_tr_b16 v[74:75], v43 offset:8448
    ds_read_b64_tr_b16 v[76:77], v43 offset:10240
    ds_read_b64_tr_b16 v[78:79], v43 offset:10496
    ds_read_b64_tr_b16 v[80:81], v44 offset:8192
    ds_read_b64_tr_b16 v[82:83], v44 offset:8448
    ds_read_b64_tr_b16 v[84:85], v44 offset:10240
    ds_read_b64_tr_b16 v[86:87], v44 offset:10496
    s_waitcnt lgkmcnt(0)
    ds_write_b128 v53, v[72:75] offset:8192
    ds_write_b128 v53, v[76:79] offset:9216
    ds_write_b128 v53, v[80:83] offset:10240
    ds_write_b128 v53, v[84:87] offset:11264
    s_waitcnt lgkmcnt(0)
    s_waitcnt vmcnt(0)
    ds_read_b64_tr_b16 v[72:73], v43 offset:12288
    ds_read_b64_tr_b16 v[74:75], v43 offset:12544
    ds_read_b64_tr_b16 v[76:77], v43 offset:14336
    ds_read_b64_tr_b16 v[78:79], v43 offset:14592
    ds_read_b64_tr_b16 v[80:81], v44 offset:12288
    ds_read_b64_tr_b16 v[82:83], v44 offset:12544
    ds_read_b64_tr_b16 v[84:85], v44 offset:14336
    ds_read_b64_tr_b16 v[86:87], v44 offset:14592
    s_waitcnt lgkmcnt(0)
    ds_write_b128 v53, v[72:75] offset:12288
    ds_write_b128 v53, v[76:79] offset:13312
    ds_write_b128 v53, v[80:83] offset:14336
    ds_write_b128 v53, v[84:87] offset:15360
    s_waitcnt lgkmcnt(0)
    s_cmp_lg_u32 s21, 0
    s_cbranch_scc1 L_tb_done
    s_mov_b64 exec, 1
    v_mov_b32 v32, 16
    s_mov_b32 s29, 0
L_tb:
    global_load_dword v33, v32, s[24:25] sc0 sc1
    s_waitcnt vmcnt(0)
    v_readfirstlane_b32 s30, v33
    s_add_u32 s29, s29, 1
    s_cmp_gt_u32 s29, 0x40000
    s_cbranch_scc1 L_tb2
    s_cmp_lt_u32 s30, 32
    s_cbranch_scc1 L_tb
L_tb2:
    s_mov_b64 exec, s[26:27]
L_tb_done:
    s_mov_b32 s40, 0
    s_mov_b32 s41, 46923776
    s_mov_b32 s96, 46940160
    s_mov_b32 s43, 46137344
    s_add_u32 s46, s97, 0
    s_add_u32 s47, s97, 16777216
    s_mov_b32 s53, 0
    s_mov_b32 s55, 0
    s_mov_b32 s37, 47775744
    s_mov_b32 s38, 47779840
    s_mov_b32 s100, 0
    s_mov_b32 s14, 0
    s_cmp_lt_u32 s14, s100
    s_cbranch_scc1 L_rdy_3
    s_mov_b32 s17, 0
L_rp_4:
    v_lshlrev_b32 v6, 8, v0
    s_lshl_b32 s29, s22, 7
    s_add_u32 s29, s29, 47005696
    s_mov_b64 exec, 0xff
    buffer_load_dword v7, v6, s[4:7], s29 offen sc0 sc1
    s_mov_b64 exec, s[26:27]
    s_waitcnt vmcnt(0)
    s_mov_b32 s15, 64
    v_readlane_b32 s16, v7, 1
    s_nop 0
    s_mul_i32 s16, s16, 7
    s_add_u32 s16, s16, 0
    s_min_u32 s15, s15, s16
    v_readlane_b32 s16, v7, 2
    s_nop 0
    s_mul_i32 s16, s16, 7
    s_add_u32 s16, s16, 1
    s_min_u32 s15, s15, s16
    v_readlane_b32 s16, v7, 3
    s_nop 0
    s_mul_i32 s16, s16, 7
    s_add_u32 s16, s16, 2
    s_min_u32 s15, s15, s16
    v_readlane_b32 s16, v7, 4
    s_nop 0
    s_mul_i32 s16, s16, 7
    s_add_u32 s16, s16, 3
    s_min_u32 s15, s15, s16
    v_readlane_b32 s16, v7, 5
    s_nop 0
    s_mul_i32 s16, s16, 7
    s_add_u32 s16, s16, 4
    s_min_u32 s15, s15, s16
    v_readlane_b32 s16, v7, 6
    s_nop 0
    s_mul_i32 s16, s16, 7
    s_add_u32 s16, s16, 5
    s_min_u32 s15, s15, s16
    v_readlane_b32 s16, v7, 7
    s_nop 0
    s_mul_i32 s16, s16, 7
    s_add_u32 s16, s16, 6
    s_min_u32 s15, s15, s16
    s_mov_b32 s100, s15
    s_add_u32 s17, s17, 1
    s_cmp_gt_u32 s17, 0x40000
    s_cbranch_scc1 L_rdy_3
    s_cmp_lt_u32 s14, s100
    s_cbranch_scc0 L_rp_4
L_rdy_3:
    s_cmp_eq_u32 s21, 1
    s_cbranch_scc0 L_pf_5
    s_add_u32 s28, s46, 0
    s_add_u32 s29, s55, 114688
    s_mov_b32 m0, s29
    s_nop 0
    buffer_load_dwordx4 v0, s[4:7], s28 offen offset:0 sc1 lds
    buffer_load_dwordx4 v0, s[4:7], s28 offen offset:1024 sc1 lds
    buffer_load_dwordx4 v0, s[4:7], s28 offen offset:2048 sc1 lds
    buffer_load_dwordx4 v0, s[4:7], s28 offen offset:3072 sc1 lds
    s_add_u32 s28, s46, 4096
    s_add_u32 s29, s55, 118784
    s_mov_b32 m0, s29
    s_nop 0
    buffer_load_dwordx4 v0, s[4:7], s28 offen offset:0 sc1 lds
    buffer_load_dwordx4 v0, s[4:7], s28 offen offset:1024 sc1 lds
    buffer_load_dwordx4 v0, s[4:7], s28 offen offset:2048 sc1 lds
    buffer_load_dwordx4 v0, s[4:7], s28 offen offset:3072 sc1 lds
L_pf_5:
    s_cmp_eq_u32 s21, 2
    s_cbranch_scc0 L_pf_6
    s_add_u32 s28, s47, 0
    s_add_u32 s29, s55, 131072
    s_mov_b32 m0, s29
    s_nop 0
    buffer_load_dwordx4 v0, s[4:7], s28 offen offset:0 sc1 lds
    buffer_load_dwordx4 v0, s[4:7], s28 offen offset:1024 sc1 lds
    buffer_load_dwordx4 v0, s[4:7], s28 offen offset:2048 sc1 lds
    buffer_load_dwordx4 v0, s[4:7], s28 offen offset:3072 sc1 lds
    s_add_u32 s28, s47, 4096
    s_add_u32 s29, s55, 135168
    s_mov_b32 m0, s29
    s_nop 0
    buffer_load_dwordx4 v0, s[4:7], s28 offen offset:0 sc1 lds
    buffer_load_dwordx4 v0, s[4:7], s28 offen offset:1024 sc1 lds
    buffer_load_dwordx4 v0, s[4:7], s28 offen offset:2048 sc1 lds
    buffer_load_dwordx4 v0, s[4:7], s28 offen offset:3072 sc1 lds
L_pf_6:
    s_waitcnt vmcnt(0)
    s_barrier
    v_mov_b32 v24, 0
    v_mov_b32 v25, 0
    v_mov_b32 v26, 0
    v_mov_b32 v27, 0
    s_nop 1
    v_mfma_f32_32x32x16_bf16 v[72:87], v[24:27], v[24:27], 0
    v_mfma_f32_16x16x32_bf16 v[88:91], v[24:27], v[24:27], 0
    v_mfma_f32_16x16x32_bf16 v[92:95], v[24:27], v[24:27], 0
    ds_read_b128 v[96:99], v5 offset:16384
    ds_read_b128 v[100:103], v5 offset:17408
    ds_read_b128 v[104:107], v5 offset:18432
    ds_read_b128 v[108:111], v5 offset:19456
    s_lshl_b32 s28, s21, 11
    s_add_u32 s45, s41, s28
    s_cmp_eq_u32 s40, 63
    s_cbranch_scc1 L_sk63_7
    s_add_u32 s14, s40, 1
    s_min_u32 s14, s14, 63
    s_cmp_lt_u32 s14, s100
    s_cbranch_scc1 L_rdy_8
    s_mov_b32 s17, 0
L_rp_9:
    v_lshlrev_b32 v6, 8, v0
    s_lshl_b32 s29, s22, 7
    s_add_u32 s29, s29, 47005696
    s_mov_b64 exec, 0xff
    buffer_load_dword v7, v6, s[4:7], s29 offen sc0 sc1
    s_mov_b64 exec, s[26:27]
    s_waitcnt vmcnt(0)
    s_mov_b32 s15, 64
    v_readlane_b32 s16, v7, 1
    s_nop 0
    s_mul_i32 s16, s16, 7
    s_add_u32 s16, s16, 0
    s_min_u32 s15, s15, s16
    v_readlane_b32 s16, v7, 2
    s_nop 0
    s_mul_i32 s16, s16, 7
    s_add_u32 s16, s16, 1
    s_min_u32 s15, s15, s16
    v_readlane_b32 s16, v7, 3
    s_nop 0
    s_mul_i32 s16, s16, 7
    s_add_u32 s16, s16, 2
    s_min_u32 s15, s15, s16
    v_readlane_b32 s16, v7, 4
    s_nop 0
    s_mul_i32 s16, s16, 7
    s_add_u32 s16, s16, 3
    s_min_u32 s15, s15, s16
    v_readlane_b32 s16, v7, 5
    s_nop 0
    s_mul_i32 s16, s16, 7
    s_add_u32 s16, s16, 4
    s_min_u32 s15, s15, s16
    v_readlane_b32 s16, v7, 6
    s_nop 0
    s_mul_i32 s16, s16, 7
    s_add_u32 s16, s16, 5
    s_min_u32 s15, s15, s16
    v_readlane_b32 s16, v7, 7
    s_nop 0
    s_mul_i32 s16, s16, 7
    s_add_u32 s16, s16, 6
    s_min_u32 s15, s15, s16
    s_mov_b32 s100, s15
    s_add_u32 s17, s17, 1
    s_cmp_gt_u32 s17, 0x40000
    s_cbranch_scc1 L_rdy_8
    s_cmp_lt_u32 s14, s100
    s_cbranch_scc0 L_rp_9
L_rdy_8:
L_sk63_7:
    s_add_u32 s46, s46, 0x40000
    s_add_u32 s47, s47, 0x40000
    s_cmp_lt_u32 s21, 2
    s_cselect_b32 s39, s46, s47
    s_lshr_b32 s29, s21, 1
    s_lshl_b32 s29, s29, 13
    s_add_u32 s29, s29, 114688
    s_lshl_b32 s19, s21, 12
    s_and_b32 s18, s19, 4096
    s_add_u32 s39, s39, s18
    s_xor_b32 s18, s55, 8192
    s_add_u32 s29, s29, s18
    s_add_u32 s29, s29, s19
    s_mov_b32 m0, s29
    s_add_u32 s12, s55, 114688
    s_lshl_b32 s28, s21, 11
    s_add_u32 s13, s28, s55
    s_add_u32 s13, s13, 131072
    s_max_u32 s34, s40, 1
    s_sub_u32 s34, s34, 1
    s_lshl_b32 s101, s22, 7
    s_add_u32 s101, s101, 46997504
    s_mov_b32 s35, s38
    s_lshl_b32 s28, s40, 16
    s_lshl_b32 s29, s22, 11
    s_add_u32 s38, s28, s29
    s_lshl_b32 s29, s21, 9
    s_add_u32 s38, s38, s29
    s_add_u32 s38, s38, 33554432
    s_mov_b32 s36, s37
    s_add_u32 s37, s38, 16777216
L_step:
    v_mov_b32 v28, 0
    v_mov_b32 v29, 0
    v_mov_b32 v30, 0
    v_mov_b32 v31, 0
    s_lshl_b32 s28, s21, 11
    v_add_u32 v8, s28, v0
    v_add_u32 v8, 147456, v8
    v_xor_b32 v9, 2048, v8
    v_xor_b32 v10, 4096, v8
    v_xor_b32 v11, 6144, v8
    buffer_load_dwordx4 v[40:43], v0, s[4:7], s45 offen offset:0 sc1
    buffer_load_dwordx4 v[44:47], v0, s[4:7], s45 offen offset:1024 sc1
    ds_read_b128 v[12:15], v5 offset:20480
    ds_read_b128 v[16:19], v5 offset:21504
    ds_read_b128 v[20:23], v5 offset:22528
    ds_read_b128 v[24:27], v5 offset:23552
L_pmA:
    s_add_u32 s53, s53, 1
    s_waitcnt vmcnt(0)
    v_max3_u32 v6, v40, v41, v42
    v_max3_u32 v7, v43, v44, v45
    v_max3_u32 v6, v6, v46, v47
    v_max_u32 v6, v6, v7
    v_cmp_eq_u32 vcc, -1, v6
    s_cmp_gt_u32 s53, 0x200000
    s_cbranch_scc1 L_goA
    s_cbranch_vccz L_goA
    buffer_load_dwordx4 v[40:43], v0, s[4:7], s45 offen offset:0 sc1
    buffer_load_dwordx4 v[44:47], v0, s[4:7], s45 offen offset:1024 sc1
    s_branch L_pmA
L_goA:
    v_smfmac_f32_16x16x64_bf16 v[72:75], v[40:43], a[0:7], v4
    ds_write_b128 v8, v[40:43]
    v_smfmac_f32_16x16x64_bf16 v[80:83], v[40:43], a[128:135], v4
    ds_write_b128 v8, v[44:47] offset:1024
    v_smfmac_f32_16x16x64_bf16 v[76:79], v[40:43], a[64:71], v4
    v_add_u32 v7, s12, v0
    v_smfmac_f32_16x16x64_bf16 v[84:87], v[40:43], a[192:199], v4
    v_smfmac_f32_16x16x64_bf16 v[72:75], v[44:47], a[8:15], v4
    v_smfmac_f32_16x16x64_bf16 v[80:83], v[44:47], a[136:143], v4
    v_smfmac_f32_16x16x64_bf16 v[76:79], v[44:47], a[72:79], v4
    v_smfmac_f32_16x16x64_bf16 v[84:87], v[44:47], a[200:207], v4
    s_waitcnt lgkmcnt(0)
    s_barrier
    ds_read_b128 v[48:51], v9 offset:0
    ds_read_b128 v[52:55], v9 offset:1024
    v_smfmac_f32_16x16x64_bf16 v[88:91], v[40:43], v[112:119], v4
    ds_read_b128 v[56:59], v10 offset:0
    v_smfmac_f32_16x16x64_bf16 v[92:95], v[40:43], v[120:127], v4
    ds_read_b128 v[60:63], v10 offset:1024
    v_smfmac_f32_16x16x64_bf16 v[88:91], v[44:47], v[96:103], v4
    ds_read_b128 v[64:67], v11 offset:0
    v_smfmac_f32_16x16x64_bf16 v[92:95], v[44:47], v[104:111], v4
    ds_read_b128 v[68:71], v11 offset:1024
L_joinP0:
    v_add_u32 v6, s13, v0
    s_waitcnt lgkmcnt(5)
    v_smfmac_f32_16x16x64_bf16 v[72:75], v[48:51], a[16:23], v4
    ds_read_b128 v[96:99], v5 offset:24576
    v_smfmac_f32_16x16x64_bf16 v[80:83], v[48:51], a[144:151], v4
    ds_read_b128 v[100:103], v5 offset:25600
    v_smfmac_f32_16x16x64_bf16 v[76:79], v[48:51], a[80:87], v4
    ds_read_b128 v[104:107], v5 offset:26624
    v_smfmac_f32_16x16x64_bf16 v[84:87], v[48:51], a[208:215], v4
    ds_read_b128 v[108:111], v5 offset:27648
    s_waitcnt lgkmcnt(8)
    v_smfmac_f32_16x16x64_bf16 v[72:75], v[52:55], a[24:31], v4
    ds_read_b128 v[40:43], v7 offset:0
    v_smfmac_f32_16x16x64_bf16 v[80:83], v[52:55], a[152:159], v4
    ds_read_b128 v[44:47], v7 offset:4096
    v_smfmac_f32_16x16x64_bf16 v[76:79], v[52:55], a[88:95], v4
    buffer_load_dwordx4 v0, s[4:7], s39 offen offset:0 sc1 lds
    v_smfmac_f32_16x16x64_bf16 v[84:87], v[52:55], a[216:223], v4
    v_smfmac_f32_16x16x64_bf16 v[88:91], v[48:51], v[12:19], v4
    buffer_load_dwordx4 v0, s[4:7], s39 offen offset:1024 sc1 lds
    v_smfmac_f32_16x16x64_bf16 v[92:95], v[48:51], v[20:27], v4
    s_waitcnt lgkmcnt(9)
    v_smfmac_f32_16x16x64_bf16 v[72:75], v[56:59], a[32:39], v4
    ds_read_b128 v[12:15], v5 offset:0
    v_smfmac_f32_16x16x64_bf16 v[80:83], v[56:59], a[160:167], v4
    ds_read_b128 v[16:19], v5 offset:1024
    v_smfmac_f32_16x16x64_bf16 v[76:79], v[56:59], a[96:103], v4
    ds_read_b128 v[20:23], v5 offset:2048
    v_smfmac_f32_16x16x64_bf16 v[84:87], v[56:59], a[224:231], v4
    ds_read_b128 v[24:27], v5 offset:3072
    s_waitcnt lgkmcnt(12)
    v_smfmac_f32_16x16x64_bf16 v[72:75], v[60:63], a[40:47], v4
    ds_read_b128 v[48:51], v7 offset:1024
    v_smfmac_f32_16x16x64_bf16 v[80:83], v[60:63], a[168:175], v4
    buffer_load_dwordx4 v0, s[4:7], s39 offen offset:2048 sc1 lds
    v_smfmac_f32_16x16x64_bf16 v[76:79], v[60:63], a[104:111], v4
    ds_read_b32 v32, v1 offset:0
    v_smfmac_f32_16x16x64_bf16 v[84:87], v[60:63], a[232:239], v4
    ds_read_b32 v33, v1 offset:512
    s_waitcnt lgkmcnt(11)
    v_smfmac_f32_16x16x64_bf16 v[88:91], v[52:55], v[96:103], v4
    buffer_load_dwordx4 v0, s[4:7], s39 offen offset:3072 sc1 lds
    s_waitcnt lgkmcnt(9)
    v_smfmac_f32_16x16x64_bf16 v[92:95], v[52:55], v[104:111], v4
    s_cmp_eq_u32 s21, 1
    s_cbranch_scc0 L_fkm_10
    v_mov_b32 v10, s34
    s_mov_b64 exec, 1
    buffer_store_dword v10, v0, s[4:7], s101 offen sc0 sc1
    s_mov_b64 exec, s[26:27]
L_fkm_10:
    v_smfmac_f32_16x16x64_bf16 v[72:75], v[64:67], a[48:55], v4
    ds_read_b128 v[96:99], v5 offset:4096
    v_smfmac_f32_16x16x64_bf16 v[80:83], v[64:67], a[176:183], v4
    ds_read_b128 v[100:103], v5 offset:5120
    v_smfmac_f32_16x16x64_bf16 v[76:79], v[64:67], a[112:119], v4
    ds_read_b128 v[104:107], v5 offset:6144
    v_smfmac_f32_16x16x64_bf16 v[84:87], v[64:67], a[240:247], v4
    ds_read_b128 v[108:111], v5 offset:7168
    s_waitcnt lgkmcnt(9)
    v_smfmac_f32_16x16x64_bf16 v[88:91], v[56:59], v[12:19], v4
    ds_read_b128 v[52:55], v7 offset:5120
    s_waitcnt lgkmcnt(8)
    v_smfmac_f32_16x16x64_bf16 v[92:95], v[56:59], v[20:27], v4
    v_lshrrev_b32 v8, 2, v0
    buffer_store_dword v37, v8, s[4:7], s36 offen offset:0 sc0 sc1
    v_smfmac_f32_16x16x64_bf16 v[72:75], v[68:71], a[56:63], v4
    ds_read_b128 v[12:15], v5 offset:8192
    v_smfmac_f32_16x16x64_bf16 v[80:83], v[68:71], a[184:191], v4
    ds_read_b128 v[16:19], v5 offset:9216
    v_smfmac_f32_16x16x64_bf16 v[76:79], v[68:71], a[120:127], v4
    ds_read_b128 v[20:23], v5 offset:10240
    v_smfmac_f32_16x16x64_bf16 v[84:87], v[68:71], a[248:255], v4
    ds_read_b128 v[24:27], v5 offset:11264
    s_waitcnt lgkmcnt(7)
    v_smfmac_f32_16x16x64_bf16 v[88:91], v[60:63], v[96:103], v4
    buffer_store_dword v38, v8, s[4:7], s36 offen offset:256 sc0 sc1
    s_waitcnt lgkmcnt(5)
    v_smfmac_f32_16x16x64_bf16 v[92:95], v[60:63], v[104:111], v4
    buffer_store_dword v32, v8, s[4:7], s35 offen offset:0 sc0 sc1
    buffer_store_dword v33, v8, s[4:7], s35 offen offset:256 sc0 sc1
    v_lshrrev_b32 v9, 1, v0
    v_add_u32 v9, 155648, v9
    v_add_f32 v80, v80, v81
    v_add_f32 v82, v82, v83
    v_add_f32 v72, v72, v73
    v_add_f32 v74, v74, v75
    v_cvt_pk_bf16_f32 v80, v80, v82
    v_cvt_pk_bf16_f32 v81, v72, v74
    ds_write_b64 v1, v[80:81] offset:0
    v_add_f32 v84, v84, v85
    v_add_f32 v86, v86, v87
    v_add_f32 v76, v76, v77
    v_add_f32 v78, v78, v79
    v_cvt_pk_bf16_f32 v84, v84, v86
    v_cvt_pk_bf16_f32 v85, v76, v78
    ds_write_b64 v1, v[84:85] offset:512
    ds_read_b128 v[96:99], v5 offset:12288
    ds_read_b128 v[100:103], v5 offset:13312
    ds_read_b128 v[104:107], v5 offset:14336
    ds_read_b128 v[108:111], v5 offset:15360
    s_waitcnt lgkmcnt(8)
    v_smfmac_f32_16x16x64_bf16 v[88:91], v[64:67], v[12:19], v4
    s_waitcnt lgkmcnt(6)
    v_smfmac_f32_16x16x64_bf16 v[92:95], v[64:67], v[20:27], v4
    s_cmp_eq_u32 s40, 63
    s_cbranch_scc1 L_tail63
    s_waitcnt lgkmcnt(4)
    s_barrier
    ds_read_b64_tr_b16 v[72:73], v9 offset:0
    ds_read_b64_tr_b16 v[74:75], v9 offset:512
    ds_read_b64_tr_b16 v[76:77], v9 offset:1024
    ds_read_b64_tr_b16 v[78:79], v9 offset:1536
    ds_read_b64_tr_b16 v[80:81], v9 offset:2048
    ds_read_b64_tr_b16 v[82:83], v9 offset:2560
    ds_read_b64_tr_b16 v[84:85], v9 offset:3072
    ds_read_b64_tr_b16 v[86:87], v9 offset:3584
    s_waitcnt lgkmcnt(6)
    v_mfma_f32_16x16x32_bf16 v[28:31], v[40:43], v[72:75], 0
    ds_read_b128 v[56:59], v7 offset:2048
    v_mfma_f32_16x16x32_bf16 v[32:35], v[44:47], v[72:75], 0
    ds_read_b128 v[60:63], v7 offset:6144
    v_mfma_f32_16x16x32_bf16 v[36:39], v[72:75], v[72:75], 0
    ds_read_b128 v[64:67], v7 offset:3072
    s_waitcnt lgkmcnt(7)
    v_mfma_f32_16x16x32_bf16 v[28:31], v[48:51], v[76:79], v[28:31]
    v_smfmac_f32_16x16x64_bf16 v[88:91], v[68:71], v[96:103], v4
    v_mfma_f32_16x16x32_bf16 v[32:35], v[52:55], v[76:79], v[32:35]
    v_smfmac_f32_16x16x64_bf16 v[92:95], v[68:71], v[104:111], v4
    v_mfma_f32_16x16x32_bf16 v[36:39], v[76:79], v[76:79], v[36:39]
    ds_read_b128 v[68:71], v7 offset:7168
    s_waitcnt lgkmcnt(6)
    s_waitcnt lgkmcnt(2)
    v_mfma_f32_16x16x32_bf16 v[28:31], v[56:59], v[80:83], v[28:31]
    ds_read_b128 v[12:15], v6 offset:0
    v_mov_b32 v24, 0
    v_mfma_f32_16x16x32_bf16 v[32:35], v[60:63], v[80:83], v[32:35]
    ds_read_b128 v[16:19], v6 offset:1024
    v_mov_b32 v25, 0
    v_mfma_f32_16x16x32_bf16 v[36:39], v[80:83], v[80:83], v[36:39]
    v_mov_b32 v26, 0
    v_mov_b32 v27, 0
    s_waitcnt lgkmcnt(2)
    v_mfma_f32_16x16x32_bf16 v[28:31], v[64:67], v[84:87], v[28:31]
    v_add_f32 v88, v88, v89
    v_add_f32 v90, v90, v91
    v_mfma_f32_16x16x32_bf16 v[32:35], v[68:71], v[84:87], v[32:35]
    v_cvt_pk_bf16_f32 v88, v88, v90
    v_mov_b32 v89, 0
    v_mfma_f32_16x16x32_bf16 v[36:39], v[84:87], v[84:87], v[36:39]
    v_add_f32 v92, v92, v93
    v_add_f32 v94, v94, v95
    v_cvt_pk_bf16_f32 v92, v92, v94
    v_mov_b32 v93, 0
    v_add_u32 v11, 159744, v0
    s_nop 0
    v_max3_f32 v6, v28, v29, v30
    v_max3_f32 v7, v32, v33, v34
    v_max3_f32 v6, v6, v31, v35
    v_max3_f32 v7, v7, v36, v37
    v_max_f32 v6, v6, v7
    v_mov_b32 v7, v6
    s_nop 1
    v_permlane16_swap_b32 v6, v7
    v_max_f32 v6, v6, v7
    v_mov_b32 v7, v6
    v_mov_b32 v39, 0
    s_nop 0
    v_permlane32_swap_b32 v6, v7
    v_max_f32 v6, v6, v7
    v_mul_f32 v6, s52, v6
    v_pk_fma_f32 v[28:29], v[28:29], s[52:53], v[6:7] op_sel_hi:[1,0,0] neg_lo:[0,0,1] neg_hi:[0,0,1]
    v_pk_fma_f32 v[30:31], v[30:31], s[52:53], v[6:7] op_sel_hi:[1,0,0] neg_lo:[0,0,1] neg_hi:[0,0,1]
    v_pk_fma_f32 v[32:33], v[32:33], s[52:53], v[6:7] op_sel_hi:[1,0,0] neg_lo:[0,0,1] neg_hi:[0,0,1]
    v_pk_fma_f32 v[34:35], v[34:35], s[52:53], v[6:7] op_sel_hi:[1,0,0] neg_lo:[0,0,1] neg_hi:[0,0,1]
    v_pk_fma_f32 v[36:37], v[36:37], s[52:53], v[6:7] op_sel_hi:[1,0,0] neg_lo:[0,0,1] neg_hi:[0,0,1]
    v_exp_f32 v28, v28
    v_exp_f32 v29, v29
    v_exp_f32 v30, v30
    v_exp_f32 v31, v31
    v_exp_f32 v32, v32
    v_exp_f32 v33, v33
    v_exp_f32 v34, v34
    v_exp_f32 v35, v35
    v_exp_f32 v36, v36
    v_add_f32 v8, v28, v29
    v_add_f32 v9, v30, v31
    v_exp_f32 v37, v37
    v_cvt_pk_bf16_f32 v28, v28, v29
    v_cvt_pk_bf16_f32 v29, v30, v31
    v_cvt_pk_bf16_f32 v30, v32, v33
    v_cvt_pk_bf16_f32 v31, v34, v35
    v_add_f32 v8, v8, v32
    v_add_f32 v9, v9, v33
    s_waitcnt lgkmcnt(0)
    v_mfma_f32_16x16x32_bf16 v[76:79], v[12:15], v[28:31], 0
    v_cvt_pk_bf16_f32 v38, v36, v37
    v_add_f32 v8, v8, v34
    v_mfma_f32_16x16x32_bf16 v[80:83], v[16:19], v[28:31], 0
    v_add_f32 v9, v9, v35
    v_add_f32 v8, v8, v36
    v_mfma_f32_16x16x16_bf16 v[76:79], v[88:89], v[38:39], v[76:79]
    v_add_f32 v9, v9, v37
    v_add_f32 v8, v8, v9
    v_mfma_f32_16x16x16_bf16 v[80:83], v[92:93], v[38:39], v[80:83]
    v_mov_b32 v9, v8
    s_nop 1
    v_permlane16_swap_b32 v8, v9
    v_add_f32 v8, v8, v9
    v_mov_b32 v9, v8
    s_nop 1
    v_permlane32_swap_b32 v8, v9
    v_add_f32 v8, v8, v9
    v_rcp_f32 v8, v8
    s_nop 0
    v_mul_f32 v76, v76, v8
    v_mul_f32 v80, v80, v8
    v_mul_f32 v77, v77, v8
    v_mul_f32 v81, v81, v8
    v_cvt_pk_bf16_f32 v72, v76, v77
    v_cvt_pk_bf16_f32 v73, v80, v81
    s_mov_b64 exec, s[50:51]
    ds_write_b64 v2, v[72:73]
    s_mov_b64 exec, s[26:27]
    v_mul_f32 v78, v78, v8
    v_mul_f32 v82, v82, v8
    v_mul_f32 v79, v79, v8
    v_mul_f32 v83, v83, v8
    v_cvt_pk_bf16_f32 v74, v78, v79
    v_cvt_pk_bf16_f32 v75, v82, v83
    s_mov_b64 exec, s[50:51]
    ds_write_b64 v2, v[74:75] offset:16
    s_mov_b64 exec, s[26:27]
    v_mov_b32 v37, v88
    v_mov_b32 v38, v92
    s_cmp_eq_u32 s40, 63
    s_cbranch_scc1 L_chain_done
    v_mfma_f32_32x32x16_bf16 v[40:55], v[24:27], v[24:27], 0
    v_mfma_f32_32x32x16_bf16 v[56:71], v[24:27], v[24:27], 0
    v_add_u32 v8, 161792, v0
    ds_read_b128 v[20:23], v8
    s_cmp_eq_u32 s21, 3
    s_cbranch_scc0 L_w3_11
    s_waitcnt vmcnt(8)
L_w3_11:
    s_waitcnt lgkmcnt(0)
    s_barrier
    ds_read_b128 v[12:15], v11 offset:0
    ds_read_b128 v[16:19], v11 offset:1024
    s_waitcnt lgkmcnt(1)
    s_waitcnt lgkmcnt(0)
    v_smfmac_f32_16x16x64_bf16 v[40:43], v[12:15], v[128:135], v4
    s_add_u32 s30, s43, 32768
    s_bfe_u32 s99, s40, 0x10001
    v_smfmac_f32_16x16x64_bf16 v[40:43], v[16:19], v[136:143], v4
    v_lshrrev_b32 v10, 2, v0
    v_and_b32 v10, 0xc0, v10
    v_smfmac_f32_16x16x64_bf16 v[44:47], v[12:15], v[144:151], v4
    v_lshlrev_b32 v9, 1, v0
    v_and_b32 v9, 32, v9
    v_smfmac_f32_16x16x64_bf16 v[44:47], v[16:19], v[152:159], v4
    v_add_u32 v10, v10, v9
    v_lshrrev_b32 v9, 3, v0
    v_smfmac_f32_16x16x64_bf16 v[48:51], v[12:15], v[160:167], v4
    v_and_b32 v9, 28, v9
    v_add_u32 v10, v10, v9
    v_smfmac_f32_16x16x64_bf16 v[48:51], v[16:19], v[168:175], v4
    v_smfmac_f32_16x16x64_bf16 v[52:55], v[12:15], v[176:183], v4
    v_add_f32 v40, v40, v41
    v_add_f32 v42, v42, v43
    v_smfmac_f32_16x16x64_bf16 v[52:55], v[16:19], v[184:191], v4
    v_cvt_pk_bf16_f32 v28, v40, v42
    v_bfi_b32 v28, 1, s99, v28
    v_smfmac_f32_16x16x64_bf16 v[56:59], v[12:15], v[192:199], v4
    v_add_f32 v44, v44, v45
    v_add_f32 v46, v46, v47
    v_smfmac_f32_16x16x64_bf16 v[56:59], v[16:19], v[200:207], v4
    v_cvt_pk_bf16_f32 v29, v44, v46
    v_smfmac_f32_16x16x64_bf16 v[60:63], v[12:15], v[208:215], v4
    v_add_f32 v48, v48, v49
    v_add_f32 v50, v50, v51
    v_smfmac_f32_16x16x64_bf16 v[60:63], v[16:19], v[216:223], v4
    v_cvt_pk_bf16_f32 v30, v48, v50
    v_smfmac_f32_16x16x64_bf16 v[64:67], v[12:15], v[224:231], v4
    v_add_f32 v52, v52, v53
    v_add_f32 v54, v54, v55
    v_smfmac_f32_16x16x64_bf16 v[64:67], v[16:19], v[232:239], v4
    v_cvt_pk_bf16_f32 v31, v52, v54
    buffer_store_dwordx4 v[28:31], v3, s[4:7], s43 offen
    v_smfmac_f32_16x16x64_bf16 v[68:71], v[12:15], v[240:247], v4
    v_add_f32 v56, v56, v57
    v_add_f32 v58, v58, v59
    v_smfmac_f32_16x16x64_bf16 v[68:71], v[16:19], v[248:255], v4
    v_cvt_pk_bf16_f32 v32, v56, v58
    v_bfi_b32 v32, 1, s99, v32
    v_add_f32 v60, v60, v61
    v_add_f32 v62, v62, v63
    v_cvt_pk_bf16_f32 v33, v60, v62
    s_add_u32 s42, s41, 8192
    s_cmp_eq_u32 s42, 46948352
    s_cselect_b32 s42, 46923776, s42
    v_add_f32 v64, v64, v65
    v_add_f32 v66, v66, v67
    v_cvt_pk_bf16_f32 v34, v64, v66
    v_add_f32 v68, v68, v69
    v_add_f32 v70, v70, v71
    v_cvt_pk_bf16_f32 v35, v68, v70
    buffer_store_dwordx4 v[32:35], v3, s[4:7], s30 offen
    s_add_u32 s44, s43, s97
    s_add_u32 s33, s44, 4096
    s_add_u32 s31, s42, s98
    s_cmp_eq_u32 s21, 3
    s_cbranch_scc0 L_nopois_12
    v_mov_b32 v36, -1
    s_add_u32 s29, s96, s98
    buffer_store_dword v36, v10, s[4:7], s29 offen
L_nopois_12:
    s_mov_b32 s96, s41
    s_mov_b32 s41, s42
    s_xor_b32 s43, s43, 0x40000
    s_xor_b32 s55, s55, 8192
    s_add_u32 s40, s40, 1
    v_mfma_f32_32x32x16_bf16 v[72:87], v[24:27], v[24:27], 0
    v_mfma_f32_16x16x32_bf16 v[88:91], v[24:27], v[24:27], 0
    v_mfma_f32_16x16x32_bf16 v[92:95], v[24:27], v[24:27], 0
    ds_read_b128 v[96:99], v5 offset:16384
    ds_read_b128 v[100:103], v5 offset:17408
    ds_read_b128 v[104:107], v5 offset:18432
    ds_read_b128 v[108:111], v5 offset:19456
    s_lshl_b32 s28, s21, 11
    s_add_u32 s45, s41, s28
    s_cmp_eq_u32 s40, 63
    s_cbranch_scc1 L_sk63_13
    s_add_u32 s14, s40, 1
    s_min_u32 s14, s14, 63
    s_cmp_lt_u32 s14, s100
    s_cbranch_scc1 L_rdy_14
    s_mov_b32 s17, 0
L_rp_15:
    v_lshlrev_b32 v6, 8, v0
    s_lshl_b32 s29, s22, 7
    s_add_u32 s29, s29, 47005696
    s_mov_b64 exec, 0xff
    buffer_load_dword v7, v6, s[4:7], s29 offen sc0 sc1
    s_mov_b64 exec, s[26:27]
    s_waitcnt vmcnt(0)
    s_mov_b32 s15, 64
    v_readlane_b32 s16, v7, 1
    s_nop 0
    s_mul_i32 s16, s16, 7
    s_add_u32 s16, s16, 0
    s_min_u32 s15, s15, s16
    v_readlane_b32 s16, v7, 2
    s_nop 0
    s_mul_i32 s16, s16, 7
    s_add_u32 s16, s16, 1
    s_min_u32 s15, s15, s16
    v_readlane_b32 s16, v7, 3
    s_nop 0
    s_mul_i32 s16, s16, 7
    s_add_u32 s16, s16, 2
    s_min_u32 s15, s15, s16
    v_readlane_b32 s16, v7, 4
    s_nop 0
    s_mul_i32 s16, s16, 7
    s_add_u32 s16, s16, 3
    s_min_u32 s15, s15, s16
    v_readlane_b32 s16, v7, 5
    s_nop 0
    s_mul_i32 s16, s16, 7
    s_add_u32 s16, s16, 4
    s_min_u32 s15, s15, s16
    v_readlane_b32 s16, v7, 6
    s_nop 0
    s_mul_i32 s16, s16, 7
    s_add_u32 s16, s16, 5
    s_min_u32 s15, s15, s16
    v_readlane_b32 s16, v7, 7
    s_nop 0
    s_mul_i32 s16, s16, 7
    s_add_u32 s16, s16, 6
    s_min_u32 s15, s15, s16
    s_mov_b32 s100, s15
    s_add_u32 s17, s17, 1
    s_cmp_gt_u32 s17, 0x40000
    s_cbranch_scc1 L_rdy_14
    s_cmp_lt_u32 s14, s100
    s_cbranch_scc0 L_rp_15
L_rdy_14:
L_sk63_13:
    s_add_u32 s46, s46, 0x40000
    s_add_u32 s47, s47, 0x40000
    s_cmp_lt_u32 s21, 2
    s_cselect_b32 s39, s46, s47
    s_lshr_b32 s29, s21, 1
    s_lshl_b32 s29, s29, 13
    s_add_u32 s29, s29, 114688
    s_lshl_b32 s19, s21, 12
    s_and_b32 s18, s19, 4096
    s_add_u32 s39, s39, s18
    s_xor_b32 s18, s55, 8192
    s_add_u32 s29, s29, s18
    s_add_u32 s29, s29, s19
    s_mov_b32 m0, s29
    s_add_u32 s12, s55, 114688
    s_lshl_b32 s28, s21, 11
    s_add_u32 s13, s28, s55
    s_add_u32 s13, s13, 131072
    s_max_u32 s34, s40, 1
    s_sub_u32 s34, s34, 1
    s_lshl_b32 s101, s22, 7
    s_add_u32 s101, s101, 46997504
    s_mov_b32 s35, s38
    s_lshl_b32 s28, s40, 16
    s_lshl_b32 s29, s22, 11
    s_add_u32 s38, s28, s29
    s_lshl_b32 s29, s21, 9
    s_add_u32 s38, s38, s29
    s_add_u32 s38, s38, 33554432
    s_mov_b32 s36, s37
    s_add_u32 s37, s38, 16777216
    s_cmp_eq_u32 s21, 0
    s_cbranch_scc0 L_red_done
L_reduce:
    buffer_load_dwordx4 v[40:43], v0, s[4:7], s44 offen offset:0 sc1
    buffer_load_dwordx4 v[44:47], v0, s[4:7], s44 offen offset:1024 sc1
    buffer_load_dwordx4 v[48:51], v0, s[4:7], s44 offen offset:2048 sc1
    buffer_load_dwordx4 v[52:55], v0, s[4:7], s44 offen offset:3072 sc1
    buffer_load_dwordx4 v[56:59], v0, s[4:7], s33 offen offset:0 sc1
    buffer_load_dwordx4 v[60:63], v0, s[4:7], s33 offen offset:1024 sc1
    buffer_load_dwordx4 v[64:67], v0, s[4:7], s33 offen offset:2048 sc1
    buffer_load_dwordx4 v[68:71], v0, s[4:7], s33 offen offset:3072 sc1
    s_waitcnt lgkmcnt(0)
    s_cmp_lg_u32 s99, 0
    s_cbranch_scc1 L_prA1
L_prA0:
    s_add_u32 s53, s53, 1
    s_waitcnt vmcnt(7)
    v_mfma_f32_16x16x32_bf16 v[24:27], v[40:43], v[20:23], 0
    s_waitcnt vmcnt(6)
    v_mfma_f32_16x16x32_bf16 v[24:27], v[44:47], v[20:23], v[24:27]
    v_bitop3_b32 v6, v40, v44, v44 bitop3:0xfe
    s_waitcnt vmcnt(5)
    v_mfma_f32_16x16x32_bf16 v[24:27], v[48:51], v[20:23], v[24:27]
    s_waitcnt vmcnt(4)
    v_mfma_f32_16x16x32_bf16 v[24:27], v[52:55], v[20:23], v[24:27]
    v_bitop3_b32 v6, v6, v48, v52 bitop3:0xfe
    s_waitcnt vmcnt(3)
    v_mfma_f32_16x16x32_bf16 v[24:27], v[56:59], v[20:23], v[24:27]
    s_waitcnt vmcnt(2)
    v_mfma_f32_16x16x32_bf16 v[24:27], v[60:63], v[20:23], v[24:27]
    v_bitop3_b32 v6, v6, v56, v60 bitop3:0xfe
    s_waitcnt vmcnt(1)
    v_mfma_f32_16x16x32_bf16 v[24:27], v[64:67], v[20:23], v[24:27]
    s_waitcnt vmcnt(0)
    v_mfma_f32_16x16x32_bf16 v[24:27], v[68:71], v[20:23], v[24:27]
    v_bitop3_b32 v6, v6, v64, v68 bitop3:0xfe
    v_and_b32 v6, 1, v6
    v_cmp_ne_u32 vcc, 0, v6
    s_cmp_gt_u32 s53, 0x200000
    s_cbranch_scc1 L_rgoA
    s_cbranch_vccz L_rgoA
L_rretry0:
    buffer_load_dwordx4 v[40:43], v0, s[4:7], s44 offen offset:0 sc1
    buffer_load_dwordx4 v[44:47], v0, s[4:7], s44 offen offset:1024 sc1
    buffer_load_dwordx4 v[48:51], v0, s[4:7], s44 offen offset:2048 sc1
    buffer_load_dwordx4 v[52:55], v0, s[4:7], s44 offen offset:3072 sc1
    buffer_load_dwordx4 v[56:59], v0, s[4:7], s33 offen offset:0 sc1
    buffer_load_dwordx4 v[60:63], v0, s[4:7], s33 offen offset:1024 sc1
    buffer_load_dwordx4 v[64:67], v0, s[4:7], s33 offen offset:2048 sc1
    buffer_load_dwordx4 v[68:71], v0, s[4:7], s33 offen offset:3072 sc1
    s_branch L_prA0
L_prA1:
    s_add_u32 s53, s53, 1
    s_waitcnt vmcnt(7)
    v_mfma_f32_16x16x32_bf16 v[24:27], v[40:43], v[20:23], 0
    s_waitcnt vmcnt(6)
    v_mfma_f32_16x16x32_bf16 v[24:27], v[44:47], v[20:23], v[24:27]
    v_bitop3_b32 v6, v40, v44, v44 bitop3:0x80
    s_waitcnt vmcnt(5)
    v_mfma_f32_16x16x32_bf16 v[24:27], v[48:51], v[20:23], v[24:27]
    s_waitcnt vmcnt(4)
    v_mfma_f32_16x16x32_bf16 v[24:27], v[52:55], v[20:23], v[24:27]
    v_bitop3_b32 v6, v6, v48, v52 bitop3:0x80
    s_waitcnt vmcnt(3)
    v_mfma_f32_16x16x32_bf16 v[24:27], v[56:59], v[20:23], v[24:27]
    s_waitcnt vmcnt(2)
    v_mfma_f32_16x16x32_bf16 v[24:27], v[60:63], v[20:23], v[24:27]
    v_bitop3_b32 v6, v6, v56, v60 bitop3:0x80
    s_waitcnt vmcnt(1)
    v_mfma_f32_16x16x32_bf16 v[24:27], v[64:67], v[20:23], v[24:27]
    s_waitcnt vmcnt(0)
    v_mfma_f32_16x16x32_bf16 v[24:27], v[68:71], v[20:23], v[24:27]
    v_bitop3_b32 v6, v6, v64, v68 bitop3:0x80
    v_and_b32 v6, 1, v6
    v_cmp_ne_u32 vcc, 1, v6
    s_cmp_gt_u32 s53, 0x200000
    s_cbranch_scc1 L_rgoA
    s_cbranch_vccz L_rgoA
L_rretry1:
    buffer_load_dwordx4 v[40:43], v0, s[4:7], s44 offen offset:0 sc1
    buffer_load_dwordx4 v[44:47], v0, s[4:7], s44 offen offset:1024 sc1
    buffer_load_dwordx4 v[48:51], v0, s[4:7], s44 offen offset:2048 sc1
    buffer_load_dwordx4 v[52:55], v0, s[4:7], s44 offen offset:3072 sc1
    buffer_load_dwordx4 v[56:59], v0, s[4:7], s33 offen offset:0 sc1
    buffer_load_dwordx4 v[60:63], v0, s[4:7], s33 offen offset:1024 sc1
    buffer_load_dwordx4 v[64:67], v0, s[4:7], s33 offen offset:2048 sc1
    buffer_load_dwordx4 v[68:71], v0, s[4:7], s33 offen offset:3072 sc1
    s_branch L_prA1
L_rgoA:
    s_nop 2
    v_cndmask_b32 v6, v26, v24, s[48:49]
    v_cndmask_b32 v7, v27, v25, s[48:49]
L_rpub:
    v_cvt_pk_bf16_f32 v6, v6, v7
    buffer_store_dword v6, v10, s[4:7], s31 offen
L_red_done:
    s_barrier
    s_cmp_lt_u32 s40, 64
    s_cbranch_scc1 L_step
    s_branch L_chain_done
L_tail63:
    s_waitcnt lgkmcnt(0)
    v_smfmac_f32_16x16x64_bf16 v[88:91], v[68:71], v[96:103], v4
    v_smfmac_f32_16x16x64_bf16 v[92:95], v[68:71], v[104:111], v4
    v_lshrrev_b32 v6, 2, v0
    buffer_store_dword v80, v6, s[4:7], s38 offen offset:0 sc0 sc1
    buffer_store_dword v84, v6, s[4:7], s38 offen offset:256 sc0 sc1
    s_nop 7
    v_add_f32 v88, v88, v89
    v_add_f32 v90, v90, v91
    v_cvt_pk_bf16_f32 v88, v88, v90
    buffer_store_dword v88, v6, s[4:7], s37 offen offset:0 sc0 sc1
    v_add_f32 v92, v92, v93
    v_add_f32 v94, v94, v95
    v_cvt_pk_bf16_f32 v92, v92, v94
    buffer_store_dword v92, v6, s[4:7], s37 offen offset:256 sc0 sc1
    s_waitcnt vmcnt(0)
    s_barrier
    s_cmp_eq_u32 s21, 1
    s_cbranch_scc0 L_end
    v_mov_b32 v6, 64
    v_mov_b32 v7, 0
    s_mov_b64 exec, 1
    buffer_store_dword v6, v7, s[4:7], s101 offen sc0 sc1
    s_mov_b64 exec, s[26:27]
    s_waitcnt vmcnt(0)
    s_branch L_end
L_chain_done:
    v_lshrrev_b32 v6, 2, v0
    ds_read_b32 v8, v1 offset:0
    ds_read_b32 v9, v1 offset:512
    buffer_store_dword v37, v6, s[4:7], s37 offen offset:0 sc0 sc1
    buffer_store_dword v38, v6, s[4:7], s37 offen offset:256 sc0 sc1
    s_waitcnt lgkmcnt(0)
    buffer_store_dword v8, v6, s[4:7], s38 offen offset:0 sc0 sc1
    buffer_store_dword v9, v6, s[4:7], s38 offen offset:256 sc0 sc1
    s_waitcnt vmcnt(0)
    s_barrier
    s_cmp_eq_u32 s21, 1
    s_cbranch_scc0 L_fkm_17
    v_mov_b32 v6, 64
    v_mov_b32 v7, 0
    s_lshl_b32 s28, s22, 7
    s_add_u32 s28, s28, 46997504
    s_mov_b64 exec, 1
    buffer_store_dword v6, v7, s[4:7], s28 offen sc0 sc1
    s_mov_b64 exec, s[26:27]
L_fkm_17:
    s_waitcnt vmcnt(0)
    s_branch L_end
L_xteam:
    v_lshlrev_b32 v0, 4, v30
    s_load_dwordx2 s[30:31], s[0:1], 48
    v_lshrrev_b32 v1, 2, v30
    v_lshrrev_b32 v2, 4, v30
    v_xor_b32 v2, v2, v30
    v_and_b32 v2, 3, v2
    v_lshlrev_b32 v2, 4, v2
    v_lshlrev_b32 v1, 10, v1
    v_add_u32 v1, v1, v2
    v_and_b32 v5, 15, v30
    v_lshrrev_b32 v2, 2, v5
    v_lshrrev_b32 v34, 4, v30
    v_xor_b32 v2, v2, v34
    v_and_b32 v2, 3, v2
    v_lshlrev_b32 v5, 2, v5
    v_add_u32 v5, v5, v2
    v_lshlrev_b32 v5, 4, v5
    s_waitcnt lgkmcnt(0)
    s_mov_b32 s12, s30
    s_mov_b32 s13, s31
    s_mov_b32 s14, 0x200000
    s_mov_b32 s15, 0x20000
    s_cmp_lg_u32 s21, 1
    s_cbranch_scc1 L_xi_18
    s_mov_b64 exec, 1
    v_mov_b32 v32, 0
    s_lshl_b32 s28, s23, 7
    s_lshl_b32 s29, s22, 2
    s_add_u32 s28, s28, s29
    s_add_u32 s28, s28, 46991360
    buffer_store_dword v32, v32, s[4:7], s28 offen
    s_waitcnt vmcnt(0)
    s_and_b32 s28, s23, 3
    s_lshl_b32 s28, s28, 6
    s_lshr_b32 s29, s23, 2
    s_lshl_b32 s29, s29, 2
    s_add_u32 s28, s28, s29
    s_add_u32 s28, s28, 16
    v_mov_b32 v32, s28
    v_mov_b32 v33, 1
    global_atomic_add v32, v33, s[24:25] sc1
    s_mov_b64 exec, s[26:27]
L_xi_18:
    s_sub_u32 s28, s23, 1
    s_lshl_b32 s28, s28, 5
    s_add_u32 s28, s28, s22
    s_lshl_b32 s28, s28, 2
    s_add_u32 s28, s28, s21
    s_mul_i32 s28, s28, 5120
    s_mov_b32 s8, s56
    s_mov_b32 s9, s57
    s_mov_b32 s10, 0x400000
    s_mov_b32 s11, 0x20000
    s_add_u32 s29, s28, 0
    buffer_load_dwordx4 v[100:103], v0, s[8:11], s29 offen
    s_add_u32 s29, s28, 1024
    buffer_load_dwordx4 v[100:103], v0, s[8:11], s29 offen
    s_add_u32 s29, s28, 2048
    buffer_load_dwordx4 v[100:103], v0, s[8:11], s29 offen
    s_add_u32 s29, s28, 3072
    buffer_load_dwordx4 v[100:103], v0, s[8:11], s29 offen
    s_add_u32 s29, s28, 4096
    buffer_load_dwordx4 v[100:103], v0, s[8:11], s29 offen
    s_mov_b32 s8, s62
    s_mov_b32 s9, s63
    s_mov_b32 s10, 0x400000
    s_mov_b32 s11, 0x20000
    s_add_u32 s29, s28, 0
    buffer_load_dwordx4 v[104:107], v0, s[8:11], s29 offen
    s_add_u32 s29, s28, 1024
    buffer_load_dwordx4 v[104:107], v0, s[8:11], s29 offen
    s_add_u32 s29, s28, 2048
    buffer_load_dwordx4 v[104:107], v0, s[8:11], s29 offen
    s_add_u32 s29, s28, 3072
    buffer_load_dwordx4 v[104:107], v0, s[8:11], s29 offen
    s_add_u32 s29, s28, 4096
    buffer_load_dwordx4 v[104:107], v0, s[8:11], s29 offen
    s_mov_b32 s38, s22
    s_sub_u32 s28, s23, 1
    s_lshl_b32 s28, s28, 5
    s_add_u32 s28, s28, s22
    s_mul_i32 s29, s28, 9363
    s_lshr_b32 s22, s29, 16
    s_mul_i32 s29, s22, 7
    s_sub_u32 s37, s28, s29
    s_lshl_b32 s97, s22, 13
    s_lshl_b32 s98, s22, 8
    s_cmp_eq_u32 s37, 0
    s_cselect_b32 s42, 10, 9
    s_mul_i32 s34, s21, 32768
    s_lshl_b32 s36, s21, 20
    v_lshrrev_b32 v32, 2, v30
    v_lshlrev_b32 v33, 13, v32
    v_lshrrev_b32 v34, 5, v30
    v_lshlrev_b32 v34, 1, v34
    v_and_b32 v35, 3, v30
    v_xor_b32 v35, v35, v34
    v_lshlrev_b32 v35, 4, v35
    v_add_u32 v33, v33, v35
    s_lshl_b32 s29, s21, 6
    s_add_u32 s28, s98, s29
    v_add_u32 v40, s28, v33
    v_lshrrev_b32 v32, 4, v30
    v_lshlrev_b32 v33, 10, v32
    s_lshl_b32 s28, s21, 8
    v_add_u32 v33, s28, v33
    v_and_b32 v34, 1, v32
    v_lshrrev_b32 v36, 1, v32
    v_lshlrev_b32 v36, 3, v36
    v_add_u32 v34, v34, v36
    v_and_b32 v35, 15, v30
    v_xor_b32 v35, v35, v34
    v_lshlrev_b32 v35, 4, v35
    v_add_u32 v41, v33, v35
    v_lshrrev_b32 v32, 5, v30
    v_lshlrev_b32 v32, 10, v32
    v_bfe_u32 v33, v30, 4, 1
    v_lshlrev_b32 v34, 9, v33
    v_add_u32 v32, v32, v34
    v_bfe_u32 v34, v30, 2, 2
    v_lshlrev_b32 v34, 6, v34
    v_add_u32 v32, v32, v34
    v_and_b32 v34, 3, v30
    v_lshlrev_b32 v34, 3, v34
    v_add_u32 v32, v32, v34
    v_add_u32 v32, s34, v32
    v_lshlrev_b32 v34, 5, v33
    v_add_u32 v43, v32, v34
    v_xor_b32 v34, 32, v34
    v_add_u32 v44, v32, v34
    v_lshrrev_b32 v32, 4, v30
    v_lshlrev_b32 v32, 10, v32
    v_bfe_u32 v34, v30, 2, 2
    v_lshlrev_b32 v35, 8, v34
    v_add_u32 v32, v32, v35
    v_and_b32 v35, 3, v30
    v_lshlrev_b32 v35, 5, v35
    v_add_u32 v32, v32, v35
    v_add_u32 v32, s34, v32
    v_bfe_u32 v33, v30, 3, 1
    v_lshlrev_b32 v33, 7, v33
    v_bfe_u32 v34, v30, 2, 1
    v_lshlrev_b32 v34, 4, v34
    v_xor_b32 v35, 0, v33
    v_xor_b32 v36, 0, v34
    v_add_u32 v35, v35, v36
    v_add_u32 v45, v32, v35
    v_xor_b32 v35, 0, v33
    v_xor_b32 v36, 16, v34
    v_add_u32 v35, v35, v36
    v_add_u32 v46, v32, v35
    v_xor_b32 v35, 128, v33
    v_xor_b32 v36, 0, v34
    v_add_u32 v35, v35, v36
    v_add_u32 v47, v32, v35
    v_xor_b32 v35, 128, v33
    v_xor_b32 v36, 16, v34
    v_add_u32 v35, v35, v36
    v_add_u32 v48, v32, v35
    v_lshlrev_b32 v32, 4, v30
    v_add_u32 v53, s34, v32
    s_lshl_b32 s35, s22, 17
    s_mov_b32 s8, s58
    s_mov_b32 s9, s59
    s_mov_b32 s10, 0x400000
    s_mov_b32 s11, 0x20000
    s_add_u32 m0, s34, 0
    s_mov_b32 s28, 0
    buffer_load_dwordx4 v40, s[8:11], s28 offen lds
    s_add_u32 m0, s34, 1024
    s_mov_b32 s28, 131072
    buffer_load_dwordx4 v40, s[8:11], s28 offen lds
    s_add_u32 m0, s34, 2048
    s_mov_b32 s28, 262144
    buffer_load_dwordx4 v40, s[8:11], s28 offen lds
    s_add_u32 m0, s34, 3072
    s_mov_b32 s28, 393216
    buffer_load_dwordx4 v40, s[8:11], s28 offen lds
    s_add_u32 m0, s34, 4096
    s_mov_b32 s28, 524288
    buffer_load_dwordx4 v40, s[8:11], s28 offen lds
    s_add_u32 m0, s34, 5120
    s_mov_b32 s28, 655360
    buffer_load_dwordx4 v40, s[8:11], s28 offen lds
    s_add_u32 m0, s34, 6144
    s_mov_b32 s28, 786432
    buffer_load_dwordx4 v40, s[8:11], s28 offen lds
    s_add_u32 m0, s34, 7168
    s_mov_b32 s28, 917504
    buffer_load_dwordx4 v40, s[8:11], s28 offen lds
    s_add_u32 m0, s34, 8192
    s_mov_b32 s28, 1048576
    buffer_load_dwordx4 v40, s[8:11], s28 offen lds
    s_add_u32 m0, s34, 9216
    s_mov_b32 s28, 1179648
    buffer_load_dwordx4 v40, s[8:11], s28 offen lds
    s_add_u32 m0, s34, 10240
    s_mov_b32 s28, 1310720
    buffer_load_dwordx4 v40, s[8:11], s28 offen lds
    s_add_u32 m0, s34, 11264
    s_mov_b32 s28, 1441792
    buffer_load_dwordx4 v40, s[8:11], s28 offen lds
    s_add_u32 m0, s34, 12288
    s_mov_b32 s28, 1572864
    buffer_load_dwordx4 v40, s[8:11], s28 offen lds
    s_add_u32 m0, s34, 13312
    s_mov_b32 s28, 1703936
    buffer_load_dwordx4 v40, s[8:11], s28 offen lds
    s_add_u32 m0, s34, 14336
    s_mov_b32 s28, 1835008
    buffer_load_dwordx4 v40, s[8:11], s28 offen lds
    s_add_u32 m0, s34, 15360
    s_mov_b32 s28, 1966080
    buffer_load_dwordx4 v40, s[8:11], s28 offen lds
    s_add_u32 m0, s34, 16384
    s_mov_b32 s28, 2097152
    buffer_load_dwordx4 v40, s[8:11], s28 offen lds
    s_add_u32 m0, s34, 17408
    s_mov_b32 s28, 2228224
    buffer_load_dwordx4 v40, s[8:11], s28 offen lds
    s_add_u32 m0, s34, 18432
    s_mov_b32 s28, 2359296
    buffer_load_dwordx4 v40, s[8:11], s28 offen lds
    s_add_u32 m0, s34, 19456
    s_mov_b32 s28, 2490368
    buffer_load_dwordx4 v40, s[8:11], s28 offen lds
    s_add_u32 m0, s34, 20480
    s_mov_b32 s28, 2621440
    buffer_load_dwordx4 v40, s[8:11], s28 offen lds
    s_add_u32 m0, s34, 21504
    s_mov_b32 s28, 2752512
    buffer_load_dwordx4 v40, s[8:11], s28 offen lds
    s_add_u32 m0, s34, 22528
    s_mov_b32 s28, 2883584
    buffer_load_dwordx4 v40, s[8:11], s28 offen lds
    s_add_u32 m0, s34, 23552
    s_mov_b32 s28, 3014656
    buffer_load_dwordx4 v40, s[8:11], s28 offen lds
    s_add_u32 m0, s34, 24576
    s_mov_b32 s28, 3145728
    buffer_load_dwordx4 v40, s[8:11], s28 offen lds
    s_add_u32 m0, s34, 25600
    s_mov_b32 s28, 3276800
    buffer_load_dwordx4 v40, s[8:11], s28 offen lds
    s_add_u32 m0, s34, 26624
    s_mov_b32 s28, 3407872
    buffer_load_dwordx4 v40, s[8:11], s28 offen lds
    s_add_u32 m0, s34, 27648
    s_mov_b32 s28, 3538944
    buffer_load_dwordx4 v40, s[8:11], s28 offen lds
    s_add_u32 m0, s34, 28672
    s_mov_b32 s28, 3670016
    buffer_load_dwordx4 v40, s[8:11], s28 offen lds
    s_add_u32 m0, s34, 29696
    s_mov_b32 s28, 3801088
    buffer_load_dwordx4 v40, s[8:11], s28 offen lds
    s_add_u32 m0, s34, 30720
    s_mov_b32 s28, 3932160
    buffer_load_dwordx4 v40, s[8:11], s28 offen lds
    s_add_u32 m0, s34, 31744
    s_mov_b32 s28, 4063232
    buffer_load_dwordx4 v40, s[8:11], s28 offen lds
    s_waitcnt vmcnt(28)
    ds_read_b64_tr_b16 a[128:129], v43 offset:0
    ds_read_b64_tr_b16 a[130:131], v43 offset:256
    ds_read_b64_tr_b16 a[132:133], v43 offset:2048
    ds_read_b64_tr_b16 a[134:135], v43 offset:2304
    ds_read_b64_tr_b16 a[192:193], v44 offset:0
    ds_read_b64_tr_b16 a[194:195], v44 offset:256
    ds_read_b64_tr_b16 a[196:197], v44 offset:2048
    ds_read_b64_tr_b16 a[198:199], v44 offset:2304
    s_waitcnt lgkmcnt(0)
    s_mov_b32 s8, s60
    s_mov_b32 s9, s61
    s_mov_b32 s10, 0x400000
    s_mov_b32 s11, 0x20000
    s_add_u32 m0, s34, 0
    s_mov_b32 s28, 0
    buffer_load_dwordx4 v40, s[8:11], s28 offen lds
    s_add_u32 m0, s34, 1024
    s_mov_b32 s28, 131072
    buffer_load_dwordx4 v40, s[8:11], s28 offen lds
    s_add_u32 m0, s34, 2048
    s_mov_b32 s28, 262144
    buffer_load_dwordx4 v40, s[8:11], s28 offen lds
    s_add_u32 m0, s34, 3072
    s_mov_b32 s28, 393216
    buffer_load_dwordx4 v40, s[8:11], s28 offen lds
    s_waitcnt vmcnt(28)
    ds_read_b64_tr_b16 a[136:137], v43 offset:4096
    ds_read_b64_tr_b16 a[138:139], v43 offset:4352
    ds_read_b64_tr_b16 a[140:141], v43 offset:6144
    ds_read_b64_tr_b16 a[142:143], v43 offset:6400
    ds_read_b64_tr_b16 a[200:201], v44 offset:4096
    ds_read_b64_tr_b16 a[202:203], v44 offset:4352
    ds_read_b64_tr_b16 a[204:205], v44 offset:6144
    ds_read_b64_tr_b16 a[206:207], v44 offset:6400
    s_waitcnt lgkmcnt(0)
    s_add_u32 m0, s34, 4096
    s_mov_b32 s28, 524288
    buffer_load_dwordx4 v40, s[8:11], s28 offen lds
    s_add_u32 m0, s34, 5120
    s_mov_b32 s28, 655360
    buffer_load_dwordx4 v40, s[8:11], s28 offen lds
    s_add_u32 m0, s34, 6144
    s_mov_b32 s28, 786432
    buffer_load_dwordx4 v40, s[8:11], s28 offen lds
    s_add_u32 m0, s34, 7168
    s_mov_b32 s28, 917504
    buffer_load_dwordx4 v40, s[8:11], s28 offen lds
    s_waitcnt vmcnt(28)
    ds_read_b64_tr_b16 a[144:145], v43 offset:8192
    ds_read_b64_tr_b16 a[146:147], v43 offset:8448
    ds_read_b64_tr_b16 a[148:149], v43 offset:10240
    ds_read_b64_tr_b16 a[150:151], v43 offset:10496
    ds_read_b64_tr_b16 a[208:209], v44 offset:8192
    ds_read_b64_tr_b16 a[210:211], v44 offset:8448
    ds_read_b64_tr_b16 a[212:213], v44 offset:10240
    ds_read_b64_tr_b16 a[214:215], v44 offset:10496
    s_waitcnt lgkmcnt(0)
    s_add_u32 m0, s34, 8192
    s_mov_b32 s28, 1048576
    buffer_load_dwordx4 v40, s[8:11], s28 offen lds
    s_add_u32 m0, s34, 9216
    s_mov_b32 s28, 1179648
    buffer_load_dwordx4 v40, s[8:11], s28 offen lds
    s_add_u32 m0, s34, 10240
    s_mov_b32 s28, 1310720
    buffer_load_dwordx4 v40, s[8:11], s28 offen lds
    s_add_u32 m0, s34, 11264
    s_mov_b32 s28, 1441792
    buffer_load_dwordx4 v40, s[8:11], s28 offen lds
    s_waitcnt vmcnt(28)
    ds_read_b64_tr_b16 a[152:153], v43 offset:12288
    ds_read_b64_tr_b16 a[154:155], v43 offset:12544
    ds_read_b64_tr_b16 a[156:157], v43 offset:14336
    ds_read_b64_tr_b16 a[158:159], v43 offset:14592
    ds_read_b64_tr_b16 a[216:217], v44 offset:12288
    ds_read_b64_tr_b16 a[218:219], v44 offset:12544
    ds_read_b64_tr_b16 a[220:221], v44 offset:14336
    ds_read_b64_tr_b16 a[222:223], v44 offset:14592
    s_waitcnt lgkmcnt(0)
    s_add_u32 m0, s34, 12288
    s_mov_b32 s28, 1572864
    buffer_load_dwordx4 v40, s[8:11], s28 offen lds
    s_add_u32 m0, s34, 13312
    s_mov_b32 s28, 1703936
    buffer_load_dwordx4 v40, s[8:11], s28 offen lds
    s_add_u32 m0, s34, 14336
    s_mov_b32 s28, 1835008
    buffer_load_dwordx4 v40, s[8:11], s28 offen lds
    s_add_u32 m0, s34, 15360
    s_mov_b32 s28, 1966080
    buffer_load_dwordx4 v40, s[8:11], s28 offen lds
    s_waitcnt vmcnt(28)
    ds_read_b64_tr_b16 a[160:161], v43 offset:16384
    ds_read_b64_tr_b16 a[162:163], v43 offset:16640
    ds_read_b64_tr_b16 a[164:165], v43 offset:18432
    ds_read_b64_tr_b16 a[166:167], v43 offset:18688
    ds_read_b64_tr_b16 a[224:225], v44 offset:16384
    ds_read_b64_tr_b16 a[226:227], v44 offset:16640
    ds_read_b64_tr_b16 a[228:229], v44 offset:18432
    ds_read_b64_tr_b16 a[230:231], v44 offset:18688
    s_waitcnt lgkmcnt(0)
    s_add_u32 m0, s34, 16384
    s_mov_b32 s28, 2097152
    buffer_load_dwordx4 v40, s[8:11], s28 offen lds
    s_add_u32 m0, s34, 17408
    s_mov_b32 s28, 2228224
    buffer_load_dwordx4 v40, s[8:11], s28 offen lds
    s_add_u32 m0, s34, 18432
    s_mov_b32 s28, 2359296
    buffer_load_dwordx4 v40, s[8:11], s28 offen lds
    s_add_u32 m0, s34, 19456
    s_mov_b32 s28, 2490368
    buffer_load_dwordx4 v40, s[8:11], s28 offen lds
    s_waitcnt vmcnt(28)
    ds_read_b64_tr_b16 a[168:169], v43 offset:20480
    ds_read_b64_tr_b16 a[170:171], v43 offset:20736
    ds_read_b64_tr_b16 a[172:173], v43 offset:22528
    ds_read_b64_tr_b16 a[174:175], v43 offset:22784
    ds_read_b64_tr_b16 a[232:233], v44 offset:20480
    ds_read_b64_tr_b16 a[234:235], v44 offset:20736
    ds_read_b64_tr_b16 a[236:237], v44 offset:22528
    ds_read_b64_tr_b16 a[238:239], v44 offset:22784
    s_waitcnt lgkmcnt(0)
    s_add_u32 m0, s34, 20480
    s_mov_b32 s28, 2621440
    buffer_load_dwordx4 v40, s[8:11], s28 offen lds
    s_add_u32 m0, s34, 21504
    s_mov_b32 s28, 2752512
    buffer_load_dwordx4 v40, s[8:11], s28 offen lds
    s_add_u32 m0, s34, 22528
    s_mov_b32 s28, 2883584
    buffer_load_dwordx4 v40, s[8:11], s28 offen lds
    s_add_u32 m0, s34, 23552
    s_mov_b32 s28, 3014656
    buffer_load_dwordx4 v40, s[8:11], s28 offen lds
    s_waitcnt vmcnt(28)
    ds_read_b64_tr_b16 a[176:177], v43 offset:24576
    ds_read_b64_tr_b16 a[178:179], v43 offset:24832
    ds_read_b64_tr_b16 a[180:181], v43 offset:26624
    ds_read_b64_tr_b16 a[182:183], v43 offset:26880
    ds_read_b64_tr_b16 a[240:241], v44 offset:24576
    ds_read_b64_tr_b16 a[242:243], v44 offset:24832
    ds_read_b64_tr_b16 a[244:245], v44 offset:26624
    ds_read_b64_tr_b16 a[246:247], v44 offset:26880
    s_waitcnt lgkmcnt(0)
    s_add_u32 m0, s34, 24576
    s_mov_b32 s28, 3145728
    buffer_load_dwordx4 v40, s[8:11], s28 offen lds
    s_add_u32 m0, s34, 25600
    s_mov_b32 s28, 3276800
    buffer_load_dwordx4 v40, s[8:11], s28 offen lds
    s_add_u32 m0, s34, 26624
    s_mov_b32 s28, 3407872
    buffer_load_dwordx4 v40, s[8:11], s28 offen lds
    s_add_u32 m0, s34, 27648
    s_mov_b32 s28, 3538944
    buffer_load_dwordx4 v40, s[8:11], s28 offen lds
    s_waitcnt vmcnt(28)
    ds_read_b64_tr_b16 a[184:185], v43 offset:28672
    ds_read_b64_tr_b16 a[186:187], v43 offset:28928
    ds_read_b64_tr_b16 a[188:189], v43 offset:30720
    ds_read_b64_tr_b16 a[190:191], v43 offset:30976
    ds_read_b64_tr_b16 a[248:249], v44 offset:28672
    ds_read_b64_tr_b16 a[250:251], v44 offset:28928
    ds_read_b64_tr_b16 a[252:253], v44 offset:30720
    ds_read_b64_tr_b16 a[254:255], v44 offset:30976
    s_waitcnt lgkmcnt(0)
    s_add_u32 m0, s34, 28672
    s_mov_b32 s28, 3670016
    buffer_load_dwordx4 v40, s[8:11], s28 offen lds
    s_add_u32 m0, s34, 29696
    s_mov_b32 s28, 3801088
    buffer_load_dwordx4 v40, s[8:11], s28 offen lds
    s_add_u32 m0, s34, 30720
    s_mov_b32 s28, 3932160
    buffer_load_dwordx4 v40, s[8:11], s28 offen lds
    s_add_u32 m0, s34, 31744
    s_mov_b32 s28, 4063232
    buffer_load_dwordx4 v40, s[8:11], s28 offen lds
    s_waitcnt vmcnt(28)
    ds_read_b64_tr_b16 v[128:129], v43 offset:0
    ds_read_b64_tr_b16 v[130:131], v43 offset:256
    ds_read_b64_tr_b16 v[132:133], v43 offset:2048
    ds_read_b64_tr_b16 v[134:135], v43 offset:2304
    ds_read_b64_tr_b16 v[192:193], v44 offset:0
    ds_read_b64_tr_b16 v[194:195], v44 offset:256
    ds_read_b64_tr_b16 v[196:197], v44 offset:2048
    ds_read_b64_tr_b16 v[198:199], v44 offset:2304
    s_waitcnt lgkmcnt(0)
    s_waitcnt vmcnt(24)
    ds_read_b64_tr_b16 v[136:137], v43 offset:4096
    ds_read_b64_tr_b16 v[138:139], v43 offset:4352
    ds_read_b64_tr_b16 v[140:141], v43 offset:6144
    ds_read_b64_tr_b16 v[142:143], v43 offset:6400
    ds_read_b64_tr_b16 v[200:201], v44 offset:4096
    ds_read_b64_tr_b16 v[202:203], v44 offset:4352
    ds_read_b64_tr_b16 v[204:205], v44 offset:6144
    ds_read_b64_tr_b16 v[206:207], v44 offset:6400
    s_waitcnt lgkmcnt(0)
    s_waitcnt vmcnt(20)
    ds_read_b64_tr_b16 v[144:145], v43 offset:8192
    ds_read_b64_tr_b16 v[146:147], v43 offset:8448
    ds_read_b64_tr_b16 v[148:149], v43 offset:10240
    ds_read_b64_tr_b16 v[150:151], v43 offset:10496
    ds_read_b64_tr_b16 v[208:209], v44 offset:8192
    ds_read_b64_tr_b16 v[210:211], v44 offset:8448
    ds_read_b64_tr_b16 v[212:213], v44 offset:10240
    ds_read_b64_tr_b16 v[214:215], v44 offset:10496
    s_waitcnt lgkmcnt(0)
    s_waitcnt vmcnt(16)
    ds_read_b64_tr_b16 v[152:153], v43 offset:12288
    ds_read_b64_tr_b16 v[154:155], v43 offset:12544
    ds_read_b64_tr_b16 v[156:157], v43 offset:14336
    ds_read_b64_tr_b16 v[158:159], v43 offset:14592
    ds_read_b64_tr_b16 v[216:217], v44 offset:12288
    ds_read_b64_tr_b16 v[218:219], v44 offset:12544
    ds_read_b64_tr_b16 v[220:221], v44 offset:14336
    ds_read_b64_tr_b16 v[222:223], v44 offset:14592
    s_waitcnt lgkmcnt(0)
    s_waitcnt vmcnt(12)
    ds_read_b64_tr_b16 v[160:161], v43 offset:16384
    ds_read_b64_tr_b16 v[162:163], v43 offset:16640
    ds_read_b64_tr_b16 v[164:165], v43 offset:18432
    ds_read_b64_tr_b16 v[166:167], v43 offset:18688
    ds_read_b64_tr_b16 v[224:225], v44 offset:16384
    ds_read_b64_tr_b16 v[226:227], v44 offset:16640
    ds_read_b64_tr_b16 v[228:229], v44 offset:18432
    ds_read_b64_tr_b16 v[230:231], v44 offset:18688
    s_waitcnt lgkmcnt(0)
    s_waitcnt vmcnt(8)
    ds_read_b64_tr_b16 v[168:169], v43 offset:20480
    ds_read_b64_tr_b16 v[170:171], v43 offset:20736
    ds_read_b64_tr_b16 v[172:173], v43 offset:22528
    ds_read_b64_tr_b16 v[174:175], v43 offset:22784
    ds_read_b64_tr_b16 v[232:233], v44 offset:20480
    ds_read_b64_tr_b16 v[234:235], v44 offset:20736
    ds_read_b64_tr_b16 v[236:237], v44 offset:22528
    ds_read_b64_tr_b16 v[238:239], v44 offset:22784
    s_waitcnt lgkmcnt(0)
    s_waitcnt vmcnt(4)
    ds_read_b64_tr_b16 v[176:177], v43 offset:24576
    ds_read_b64_tr_b16 v[178:179], v43 offset:24832
    ds_read_b64_tr_b16 v[180:181], v43 offset:26624
    ds_read_b64_tr_b16 v[182:183], v43 offset:26880
    ds_read_b64_tr_b16 v[240:241], v44 offset:24576
    ds_read_b64_tr_b16 v[242:243], v44 offset:24832
    ds_read_b64_tr_b16 v[244:245], v44 offset:26624
    ds_read_b64_tr_b16 v[246:247], v44 offset:26880
    s_waitcnt lgkmcnt(0)
    s_waitcnt vmcnt(0)
    ds_read_b64_tr_b16 v[184:185], v43 offset:28672
    ds_read_b64_tr_b16 v[186:187], v43 offset:28928
    ds_read_b64_tr_b16 v[188:189], v43 offset:30720
    ds_read_b64_tr_b16 v[190:191], v43 offset:30976
    ds_read_b64_tr_b16 v[248:249], v44 offset:28672
    ds_read_b64_tr_b16 v[250:251], v44 offset:28928
    ds_read_b64_tr_b16 v[252:253], v44 offset:30720
    ds_read_b64_tr_b16 v[254:255], v44 offset:30976
    s_waitcnt lgkmcnt(0)
    s_barrier
    s_mov_b32 s40, s37
    s_mov_b32 s41, 0
    s_mov_b32 s43, 0
    s_lshr_b32 s28, s21, 1
    s_lshl_b32 s29, s40, 15
    s_lshl_b32 s30, s28, 14
    s_add_u32 s29, s29, s30
    s_and_b32 s30, s21, 1
    s_lshl_b32 s31, s30, 9
    s_add_u32 s29, s29, s31
    s_lshl_b32 s31, s21, 13
    s_add_u32 s31, s31, s43
    s_add_u32 m0, s31, 0
    s_add_u32 s30, s29, 0
    buffer_load_dwordx4 v1, s[12:15], s30 offen lds
    s_add_u32 m0, s31, 1024
    s_add_u32 s30, s29, 64
    buffer_load_dwordx4 v1, s[12:15], s30 offen lds
    s_add_u32 m0, s31, 2048
    s_add_u32 s30, s29, 128
    buffer_load_dwordx4 v1, s[12:15], s30 offen lds
    s_add_u32 m0, s31, 3072
    s_add_u32 s30, s29, 192
    buffer_load_dwordx4 v1, s[12:15], s30 offen lds
    s_add_u32 m0, s31, 4096
    s_add_u32 s30, s29, 256
    buffer_load_dwordx4 v1, s[12:15], s30 offen lds
    s_add_u32 m0, s31, 5120
    s_add_u32 s30, s29, 320
    buffer_load_dwordx4 v1, s[12:15], s30 offen lds
    s_add_u32 m0, s31, 6144
    s_add_u32 s30, s29, 384
    buffer_load_dwordx4 v1, s[12:15], s30 offen lds
    s_add_u32 m0, s31, 7168
    s_add_u32 s30, s29, 448
    buffer_load_dwordx4 v1, s[12:15], s30 offen lds
    s_cmp_lg_u32 s21, 0
    s_cbranch_scc1 L_x1_init_x
    s_mov_b64 exec, 1
    v_mov_b32 v32, 24
    s_mov_b32 s29, 0
L_x1_init:
    global_load_dword v33, v32, s[24:25] sc0 sc1
    s_waitcnt vmcnt(0)
    v_readfirstlane_b32 s30, v33
    s_add_u32 s29, s29, 1
    s_cmp_gt_u32 s29, 0x40000
    s_cbranch_scc1 L_x1_init_d
    s_cmp_ge_u32 s30, 32
    s_cbranch_scc1 L_x1_init_d
    s_sleep 8
    s_branch L_x1_init
L_x1_init_d:
    s_mov_b64 exec, s[26:27]
L_x1_init_x:
L_x1:
    s_waitcnt vmcnt(4)
    s_cmp_lg_u32 s41, 0
    s_cbranch_scc1 L_x1a_19
    s_waitcnt vmcnt(0)
L_x1a_19:
    s_barrier
    s_cmp_lt_u32 s41, 2
    s_cbranch_scc1 L_x1f_20
    s_cmp_lg_u32 s21, 0
    s_cbranch_scc1 L_x1f_20
    s_sub_u32 s28, s41, 1
    v_mov_b32 v32, s28
    v_mov_b32 v33, 0
    s_lshl_b32 s28, s37, 12
    s_lshl_b32 s29, s22, 7
    s_add_u32 s28, s28, s29
    s_add_u32 s28, s28, 47009792
    s_mov_b64 exec, 1
    buffer_store_dword v32, v33, s[4:7], s28 offen sc0 sc1
    s_mov_b64 exec, s[26:27]
L_x1f_20:
    s_add_u32 s32, s41, 1
    s_cmp_ge_u32 s32, s42
    s_cbranch_scc1 L_x1n_21
    s_add_u32 s33, s40, 7
    s_xor_b32 s36, s43, 32768
    s_lshr_b32 s28, s21, 1
    s_lshl_b32 s29, s33, 15
    s_lshl_b32 s30, s28, 14
    s_add_u32 s29, s29, s30
    s_and_b32 s30, s21, 1
    s_lshl_b32 s31, s30, 9
    s_add_u32 s29, s29, s31
    s_lshl_b32 s31, s21, 13
    s_add_u32 s31, s31, s36
    s_add_u32 m0, s31, 0
    s_add_u32 s30, s29, 0
    buffer_load_dwordx4 v1, s[12:15], s30 offen lds
    s_add_u32 m0, s31, 1024
    s_add_u32 s30, s29, 64
    buffer_load_dwordx4 v1, s[12:15], s30 offen lds
    s_add_u32 m0, s31, 2048
    s_add_u32 s30, s29, 128
    buffer_load_dwordx4 v1, s[12:15], s30 offen lds
    s_add_u32 m0, s31, 3072
    s_add_u32 s30, s29, 192
    buffer_load_dwordx4 v1, s[12:15], s30 offen lds
    s_add_u32 m0, s31, 4096
    s_add_u32 s30, s29, 256
    buffer_load_dwordx4 v1, s[12:15], s30 offen lds
    s_add_u32 m0, s31, 5120
    s_add_u32 s30, s29, 320
    buffer_load_dwordx4 v1, s[12:15], s30 offen lds
    s_add_u32 m0, s31, 6144
    s_add_u32 s30, s29, 384
    buffer_load_dwordx4 v1, s[12:15], s30 offen lds
    s_add_u32 m0, s31, 7168
    s_add_u32 s30, s29, 448
    buffer_load_dwordx4 v1, s[12:15], s30 offen lds
L_x1n_21:
    v_add_u32 v2, s43, v5
    ds_read_b128 v[72:75], v2 offset:0
    ds_read_b128 v[76:79], v2 offset:16384
    ds_read_b128 v[80:83], v2 offset:1024
    ds_read_b128 v[84:87], v2 offset:17408
    s_waitcnt lgkmcnt(2)
    v_mfma_f32_16x16x32_bf16 v[40:43], a[128:131], v[72:75], 0
    v_mfma_f32_16x16x32_bf16 v[56:59], v[72:75], v[128:131], 0
    v_mfma_f32_16x16x32_bf16 v[44:47], a[128:131], v[76:79], 0
    v_mfma_f32_16x16x32_bf16 v[60:63], v[76:79], v[128:131], 0
    v_mfma_f32_16x16x32_bf16 v[48:51], a[192:195], v[72:75], 0
    v_mfma_f32_16x16x32_bf16 v[64:67], v[72:75], v[192:195], 0
    v_mfma_f32_16x16x32_bf16 v[52:55], a[192:195], v[76:79], 0
    v_mfma_f32_16x16x32_bf16 v[68:71], v[76:79], v[192:195], 0
    ds_read_b128 v[72:75], v2 offset:2048
    ds_read_b128 v[76:79], v2 offset:18432
    s_waitcnt lgkmcnt(2)
    v_mfma_f32_16x16x32_bf16 v[40:43], a[132:135], v[80:83], v[40:43]
    v_mfma_f32_16x16x32_bf16 v[56:59], v[80:83], v[132:135], v[56:59]
    v_mfma_f32_16x16x32_bf16 v[44:47], a[132:135], v[84:87], v[44:47]
    v_mfma_f32_16x16x32_bf16 v[60:63], v[84:87], v[132:135], v[60:63]
    v_mfma_f32_16x16x32_bf16 v[48:51], a[196:199], v[80:83], v[48:51]
    v_mfma_f32_16x16x32_bf16 v[64:67], v[80:83], v[196:199], v[64:67]
    v_mfma_f32_16x16x32_bf16 v[52:55], a[196:199], v[84:87], v[52:55]
    v_mfma_f32_16x16x32_bf16 v[68:71], v[84:87], v[196:199], v[68:71]
    ds_read_b128 v[80:83], v2 offset:3072
    ds_read_b128 v[84:87], v2 offset:19456
    s_waitcnt lgkmcnt(2)
    v_mfma_f32_16x16x32_bf16 v[40:43], a[136:139], v[72:75], v[40:43]
    v_mfma_f32_16x16x32_bf16 v[56:59], v[72:75], v[136:139], v[56:59]
    v_mfma_f32_16x16x32_bf16 v[44:47], a[136:139], v[76:79], v[44:47]
    v_mfma_f32_16x16x32_bf16 v[60:63], v[76:79], v[136:139], v[60:63]
    v_mfma_f32_16x16x32_bf16 v[48:51], a[200:203], v[72:75], v[48:51]
    v_mfma_f32_16x16x32_bf16 v[64:67], v[72:75], v[200:203], v[64:67]
    v_mfma_f32_16x16x32_bf16 v[52:55], a[200:203], v[76:79], v[52:55]
    v_mfma_f32_16x16x32_bf16 v[68:71], v[76:79], v[200:203], v[68:71]
    ds_read_b128 v[72:75], v2 offset:4096
    ds_read_b128 v[76:79], v2 offset:20480
    s_waitcnt lgkmcnt(2)
    v_mfma_f32_16x16x32_bf16 v[40:43], a[140:143], v[80:83], v[40:43]
    v_mfma_f32_16x16x32_bf16 v[56:59], v[80:83], v[140:143], v[56:59]
    v_mfma_f32_16x16x32_bf16 v[44:47], a[140:143], v[84:87], v[44:47]
    v_mfma_f32_16x16x32_bf16 v[60:63], v[84:87], v[140:143], v[60:63]
    v_mfma_f32_16x16x32_bf16 v[48:51], a[204:207], v[80:83], v[48:51]
    v_mfma_f32_16x16x32_bf16 v[64:67], v[80:83], v[204:207], v[64:67]
    v_mfma_f32_16x16x32_bf16 v[52:55], a[204:207], v[84:87], v[52:55]
    v_mfma_f32_16x16x32_bf16 v[68:71], v[84:87], v[204:207], v[68:71]
    ds_read_b128 v[80:83], v2 offset:5120
    ds_read_b128 v[84:87], v2 offset:21504
    s_waitcnt lgkmcnt(2)
    v_mfma_f32_16x16x32_bf16 v[40:43], a[144:147], v[72:75], v[40:43]
    v_mfma_f32_16x16x32_bf16 v[56:59], v[72:75], v[144:147], v[56:59]
    v_mfma_f32_16x16x32_bf16 v[44:47], a[144:147], v[76:79], v[44:47]
    v_mfma_f32_16x16x32_bf16 v[60:63], v[76:79], v[144:147], v[60:63]
    v_mfma_f32_16x16x32_bf16 v[48:51], a[208:211], v[72:75], v[48:51]
    v_mfma_f32_16x16x32_bf16 v[64:67], v[72:75], v[208:211], v[64:67]
    v_mfma_f32_16x16x32_bf16 v[52:55], a[208:211], v[76:79], v[52:55]
    v_mfma_f32_16x16x32_bf16 v[68:71], v[76:79], v[208:211], v[68:71]
    ds_read_b128 v[72:75], v2 offset:6144
    ds_read_b128 v[76:79], v2 offset:22528
    s_waitcnt lgkmcnt(2)
    v_mfma_f32_16x16x32_bf16 v[40:43], a[148:151], v[80:83], v[40:43]
    v_mfma_f32_16x16x32_bf16 v[56:59], v[80:83], v[148:151], v[56:59]
    v_mfma_f32_16x16x32_bf16 v[44:47], a[148:151], v[84:87], v[44:47]
    v_mfma_f32_16x16x32_bf16 v[60:63], v[84:87], v[148:151], v[60:63]
    v_mfma_f32_16x16x32_bf16 v[48:51], a[212:215], v[80:83], v[48:51]
    v_mfma_f32_16x16x32_bf16 v[64:67], v[80:83], v[212:215], v[64:67]
    v_mfma_f32_16x16x32_bf16 v[52:55], a[212:215], v[84:87], v[52:55]
    v_mfma_f32_16x16x32_bf16 v[68:71], v[84:87], v[212:215], v[68:71]
    ds_read_b128 v[80:83], v2 offset:7168
    ds_read_b128 v[84:87], v2 offset:23552
    s_waitcnt lgkmcnt(2)
    v_mfma_f32_16x16x32_bf16 v[40:43], a[152:155], v[72:75], v[40:43]
    v_mfma_f32_16x16x32_bf16 v[56:59], v[72:75], v[152:155], v[56:59]
    v_mfma_f32_16x16x32_bf16 v[44:47], a[152:155], v[76:79], v[44:47]
    v_mfma_f32_16x16x32_bf16 v[60:63], v[76:79], v[152:155], v[60:63]
    v_mfma_f32_16x16x32_bf16 v[48:51], a[216:219], v[72:75], v[48:51]
    v_mfma_f32_16x16x32_bf16 v[64:67], v[72:75], v[216:219], v[64:67]
    v_mfma_f32_16x16x32_bf16 v[52:55], a[216:219], v[76:79], v[52:55]
    v_mfma_f32_16x16x32_bf16 v[68:71], v[76:79], v[216:219], v[68:71]
    ds_read_b128 v[72:75], v2 offset:8192
    ds_read_b128 v[76:79], v2 offset:24576
    s_waitcnt lgkmcnt(2)
    v_mfma_f32_16x16x32_bf16 v[40:43], a[156:159], v[80:83], v[40:43]
    v_mfma_f32_16x16x32_bf16 v[56:59], v[80:83], v[156:159], v[56:59]
    v_mfma_f32_16x16x32_bf16 v[44:47], a[156:159], v[84:87], v[44:47]
    v_mfma_f32_16x16x32_bf16 v[60:63], v[84:87], v[156:159], v[60:63]
    v_mfma_f32_16x16x32_bf16 v[48:51], a[220:223], v[80:83], v[48:51]
    v_mfma_f32_16x16x32_bf16 v[64:67], v[80:83], v[220:223], v[64:67]
    v_mfma_f32_16x16x32_bf16 v[52:55], a[220:223], v[84:87], v[52:55]
    v_mfma_f32_16x16x32_bf16 v[68:71], v[84:87], v[220:223], v[68:71]
    ds_read_b128 v[80:83], v2 offset:9216
    ds_read_b128 v[84:87], v2 offset:25600
    s_waitcnt lgkmcnt(2)
    v_mfma_f32_16x16x32_bf16 v[40:43], a[160:163], v[72:75], v[40:43]
    v_mfma_f32_16x16x32_bf16 v[56:59], v[72:75], v[160:163], v[56:59]
    v_mfma_f32_16x16x32_bf16 v[44:47], a[160:163], v[76:79], v[44:47]
    v_mfma_f32_16x16x32_bf16 v[60:63], v[76:79], v[160:163], v[60:63]
    v_mfma_f32_16x16x32_bf16 v[48:51], a[224:227], v[72:75], v[48:51]
    v_mfma_f32_16x16x32_bf16 v[64:67], v[72:75], v[224:227], v[64:67]
    v_mfma_f32_16x16x32_bf16 v[52:55], a[224:227], v[76:79], v[52:55]
    v_mfma_f32_16x16x32_bf16 v[68:71], v[76:79], v[224:227], v[68:71]
    ds_read_b128 v[72:75], v2 offset:10240
    ds_read_b128 v[76:79], v2 offset:26624
    s_waitcnt lgkmcnt(2)
    v_mfma_f32_16x16x32_bf16 v[40:43], a[164:167], v[80:83], v[40:43]
    v_mfma_f32_16x16x32_bf16 v[56:59], v[80:83], v[164:167], v[56:59]
    v_mfma_f32_16x16x32_bf16 v[44:47], a[164:167], v[84:87], v[44:47]
    v_mfma_f32_16x16x32_bf16 v[60:63], v[84:87], v[164:167], v[60:63]
    v_mfma_f32_16x16x32_bf16 v[48:51], a[228:231], v[80:83], v[48:51]
    v_mfma_f32_16x16x32_bf16 v[64:67], v[80:83], v[228:231], v[64:67]
    v_mfma_f32_16x16x32_bf16 v[52:55], a[228:231], v[84:87], v[52:55]
    v_mfma_f32_16x16x32_bf16 v[68:71], v[84:87], v[228:231], v[68:71]
    ds_read_b128 v[80:83], v2 offset:11264
    ds_read_b128 v[84:87], v2 offset:27648
    s_waitcnt lgkmcnt(2)
    v_mfma_f32_16x16x32_bf16 v[40:43], a[168:171], v[72:75], v[40:43]
    v_mfma_f32_16x16x32_bf16 v[56:59], v[72:75], v[168:171], v[56:59]
    v_mfma_f32_16x16x32_bf16 v[44:47], a[168:171], v[76:79], v[44:47]
    v_mfma_f32_16x16x32_bf16 v[60:63], v[76:79], v[168:171], v[60:63]
    v_mfma_f32_16x16x32_bf16 v[48:51], a[232:235], v[72:75], v[48:51]
    v_mfma_f32_16x16x32_bf16 v[64:67], v[72:75], v[232:235], v[64:67]
    v_mfma_f32_16x16x32_bf16 v[52:55], a[232:235], v[76:79], v[52:55]
    v_mfma_f32_16x16x32_bf16 v[68:71], v[76:79], v[232:235], v[68:71]
    ds_read_b128 v[72:75], v2 offset:12288
    ds_read_b128 v[76:79], v2 offset:28672
    s_waitcnt lgkmcnt(2)
    v_mfma_f32_16x16x32_bf16 v[40:43], a[172:175], v[80:83], v[40:43]
    v_mfma_f32_16x16x32_bf16 v[56:59], v[80:83], v[172:175], v[56:59]
    v_mfma_f32_16x16x32_bf16 v[44:47], a[172:175], v[84:87], v[44:47]
    v_mfma_f32_16x16x32_bf16 v[60:63], v[84:87], v[172:175], v[60:63]
    v_mfma_f32_16x16x32_bf16 v[48:51], a[236:239], v[80:83], v[48:51]
    v_mfma_f32_16x16x32_bf16 v[64:67], v[80:83], v[236:239], v[64:67]
    v_mfma_f32_16x16x32_bf16 v[52:55], a[236:239], v[84:87], v[52:55]
    v_mfma_f32_16x16x32_bf16 v[68:71], v[84:87], v[236:239], v[68:71]
    ds_read_b128 v[80:83], v2 offset:13312
    ds_read_b128 v[84:87], v2 offset:29696
    s_waitcnt lgkmcnt(2)
    v_mfma_f32_16x16x32_bf16 v[40:43], a[176:179], v[72:75], v[40:43]
    v_mfma_f32_16x16x32_bf16 v[56:59], v[72:75], v[176:179], v[56:59]
    v_mfma_f32_16x16x32_bf16 v[44:47], a[176:179], v[76:79], v[44:47]
    v_mfma_f32_16x16x32_bf16 v[60:63], v[76:79], v[176:179], v[60:63]
    v_mfma_f32_16x16x32_bf16 v[48:51], a[240:243], v[72:75], v[48:51]
    v_mfma_f32_16x16x32_bf16 v[64:67], v[72:75], v[240:243], v[64:67]
    v_mfma_f32_16x16x32_bf16 v[52:55], a[240:243], v[76:79], v[52:55]
    v_mfma_f32_16x16x32_bf16 v[68:71], v[76:79], v[240:243], v[68:71]
    ds_read_b128 v[72:75], v2 offset:14336
    ds_read_b128 v[76:79], v2 offset:30720
    s_waitcnt lgkmcnt(2)
    v_mfma_f32_16x16x32_bf16 v[40:43], a[180:183], v[80:83], v[40:43]
    v_mfma_f32_16x16x32_bf16 v[56:59], v[80:83], v[180:183], v[56:59]
    v_mfma_f32_16x16x32_bf16 v[44:47], a[180:183], v[84:87], v[44:47]
    v_mfma_f32_16x16x32_bf16 v[60:63], v[84:87], v[180:183], v[60:63]
    v_mfma_f32_16x16x32_bf16 v[48:51], a[244:247], v[80:83], v[48:51]
    v_mfma_f32_16x16x32_bf16 v[64:67], v[80:83], v[244:247], v[64:67]
    v_mfma_f32_16x16x32_bf16 v[52:55], a[244:247], v[84:87], v[52:55]
    v_mfma_f32_16x16x32_bf16 v[68:71], v[84:87], v[244:247], v[68:71]
    ds_read_b128 v[80:83], v2 offset:15360
    ds_read_b128 v[84:87], v2 offset:31744
    s_waitcnt lgkmcnt(2)
    v_mfma_f32_16x16x32_bf16 v[40:43], a[184:187], v[72:75], v[40:43]
    v_mfma_f32_16x16x32_bf16 v[56:59], v[72:75], v[184:187], v[56:59]
    v_mfma_f32_16x16x32_bf16 v[44:47], a[184:187], v[76:79], v[44:47]
    v_mfma_f32_16x16x32_bf16 v[60:63], v[76:79], v[184:187], v[60:63]
    v_mfma_f32_16x16x32_bf16 v[48:51], a[248:251], v[72:75], v[48:51]
    v_mfma_f32_16x16x32_bf16 v[64:67], v[72:75], v[248:251], v[64:67]
    v_mfma_f32_16x16x32_bf16 v[52:55], a[248:251], v[76:79], v[52:55]
    v_mfma_f32_16x16x32_bf16 v[68:71], v[76:79], v[248:251], v[68:71]
    s_waitcnt lgkmcnt(0)
    v_mfma_f32_16x16x32_bf16 v[40:43], a[188:191], v[80:83], v[40:43]
    v_mfma_f32_16x16x32_bf16 v[56:59], v[80:83], v[188:191], v[56:59]
    v_mfma_f32_16x16x32_bf16 v[44:47], a[188:191], v[84:87], v[44:47]
    v_mfma_f32_16x16x32_bf16 v[60:63], v[84:87], v[188:191], v[60:63]
    v_mfma_f32_16x16x32_bf16 v[48:51], a[252:255], v[80:83], v[48:51]
    v_mfma_f32_16x16x32_bf16 v[64:67], v[80:83], v[252:255], v[64:67]
    v_mfma_f32_16x16x32_bf16 v[52:55], a[252:255], v[84:87], v[52:55]
    v_mfma_f32_16x16x32_bf16 v[68:71], v[84:87], v[252:255], v[68:71]
    s_nop 7
    v_cvt_pk_bf16_f32 v88, v40, v41
    v_cvt_pk_bf16_f32 v89, v42, v43
    v_cvt_pk_bf16_f32 v90, v48, v49
    v_cvt_pk_bf16_f32 v91, v50, v51
    v_cvt_pk_bf16_f32 v92, v44, v45
    v_cvt_pk_bf16_f32 v93, v46, v47
    v_cvt_pk_bf16_f32 v94, v52, v53
    v_cvt_pk_bf16_f32 v95, v54, v55
    v_cvt_pk_bf16_f32 v96, v56, v57
    v_cvt_pk_bf16_f32 v97, v58, v59
    v_cvt_pk_bf16_f32 v98, v60, v61
    v_cvt_pk_bf16_f32 v99, v62, v63
    v_cvt_pk_bf16_f32 v100, v64, v65
    v_cvt_pk_bf16_f32 v101, v66, v67
    v_cvt_pk_bf16_f32 v102, v68, v69
    v_cvt_pk_bf16_f32 v103, v70, v71
    s_lshl_b32 s28, s40, 18
    s_add_u32 s28, s28, s97
    s_lshl_b32 s29, s21, 10
    s_add_u32 s29, s29, s28
    s_add_u32 s30, s29, 4096
    s_add_u32 s29, s29, 0
    buffer_store_dwordx4 v[88:91], v0, s[4:7], s29 offen sc0 sc1
    buffer_store_dwordx4 v[92:95], v0, s[4:7], s30 offen sc0 sc1
    s_lshl_b32 s29, s21, 11
    s_add_u32 s29, s29, s28
    s_add_u32 s29, s29, 16777216
    buffer_store_dwordx4 v[96:99], v0, s[4:7], s29 offen sc0 sc1
    buffer_store_dwordx4 v[100:103], v0, s[4:7], s29 offen offset:1024 sc0 sc1
    s_cmp_lg_u32 s41, 0
    s_cbranch_scc1 L_x1f0_22
    s_waitcnt vmcnt(0)
    s_barrier
    s_cmp_lg_u32 s21, 0
    s_cbranch_scc1 L_x1f0_22
    v_mov_b32 v32, 1
    v_mov_b32 v33, 0
    s_lshl_b32 s28, s37, 12
    s_lshl_b32 s29, s22, 7
    s_add_u32 s28, s28, s29
    s_add_u32 s28, s28, 47009792
    s_mov_b64 exec, 1
    buffer_store_dword v32, v33, s[4:7], s28 offen sc0 sc1
    s_mov_b64 exec, s[26:27]
L_x1f0_22:
    s_add_u32 s40, s40, 7
    s_xor_b32 s43, s43, 32768
    s_add_u32 s41, s41, 1
    s_cmp_lt_u32 s41, s42
    s_cbranch_scc1 L_x1
    s_waitcnt vmcnt(0)
    s_barrier
    s_cmp_lg_u32 s21, 0
    s_cbranch_scc1 L_x1g_23
    v_mov_b32 v32, s42
    v_mov_b32 v33, 0
    s_lshl_b32 s28, s37, 12
    s_lshl_b32 s29, s22, 7
    s_add_u32 s28, s28, s29
    s_add_u32 s28, s28, 47009792
    s_mov_b64 exec, 1
    buffer_store_dword v32, v33, s[4:7], s28 offen sc0 sc1
    s_mov_b64 exec, s[26:27]
L_x1g_23:
    s_waitcnt vmcnt(0)
    s_mov_b32 s22, s38
    s_lshl_b32 s97, s22, 13
    s_lshl_b32 s98, s22, 8
    s_cmp_eq_u32 s23, 1
    s_cselect_b32 s42, 10, 9
    s_barrier
    v_lshrrev_b32 v30, 4, v0
    s_mul_i32 s34, s21, 32768
    s_lshl_b32 s36, s21, 20
    v_lshrrev_b32 v32, 2, v30
    v_lshlrev_b32 v33, 13, v32
    v_lshrrev_b32 v34, 5, v30
    v_lshlrev_b32 v34, 1, v34
    v_and_b32 v35, 3, v30
    v_xor_b32 v35, v35, v34
    v_lshlrev_b32 v35, 4, v35
    v_add_u32 v33, v33, v35
    s_lshl_b32 s29, s21, 6
    s_add_u32 s28, s98, s29
    v_add_u32 v40, s28, v33
    v_lshrrev_b32 v32, 4, v30
    v_lshlrev_b32 v33, 10, v32
    s_lshl_b32 s28, s21, 8
    v_add_u32 v33, s28, v33
    v_and_b32 v34, 1, v32
    v_lshrrev_b32 v36, 1, v32
    v_lshlrev_b32 v36, 3, v36
    v_add_u32 v34, v34, v36
    v_and_b32 v35, 15, v30
    v_xor_b32 v35, v35, v34
    v_lshlrev_b32 v35, 4, v35
    v_add_u32 v41, v33, v35
    v_lshrrev_b32 v32, 5, v30
    v_lshlrev_b32 v32, 10, v32
    v_bfe_u32 v33, v30, 4, 1
    v_lshlrev_b32 v34, 9, v33
    v_add_u32 v32, v32, v34
    v_bfe_u32 v34, v30, 2, 2
    v_lshlrev_b32 v34, 6, v34
    v_add_u32 v32, v32, v34
    v_and_b32 v34, 3, v30
    v_lshlrev_b32 v34, 3, v34
    v_add_u32 v32, v32, v34
    v_add_u32 v32, s34, v32
    v_lshlrev_b32 v34, 5, v33
    v_add_u32 v43, v32, v34
    v_xor_b32 v34, 32, v34
    v_add_u32 v44, v32, v34
    v_lshrrev_b32 v32, 4, v30
    v_lshlrev_b32 v32, 10, v32
    v_bfe_u32 v34, v30, 2, 2
    v_lshlrev_b32 v35, 8, v34
    v_add_u32 v32, v32, v35
    v_and_b32 v35, 3, v30
    v_lshlrev_b32 v35, 5, v35
    v_add_u32 v32, v32, v35
    v_add_u32 v32, s34, v32
    v_bfe_u32 v33, v30, 3, 1
    v_lshlrev_b32 v33, 7, v33
    v_bfe_u32 v34, v30, 2, 1
    v_lshlrev_b32 v34, 4, v34
    v_xor_b32 v35, 0, v33
    v_xor_b32 v36, 0, v34
    v_add_u32 v35, v35, v36
    v_add_u32 v45, v32, v35
    v_xor_b32 v35, 0, v33
    v_xor_b32 v36, 16, v34
    v_add_u32 v35, v35, v36
    v_add_u32 v46, v32, v35
    v_xor_b32 v35, 128, v33
    v_xor_b32 v36, 0, v34
    v_add_u32 v35, v35, v36
    v_add_u32 v47, v32, v35
    v_xor_b32 v35, 128, v33
    v_xor_b32 v36, 16, v34
    v_add_u32 v35, v35, v36
    v_add_u32 v48, v32, v35
    v_lshlrev_b32 v32, 4, v30
    v_add_u32 v53, s34, v32
    s_lshl_b32 s35, s22, 17
    s_mov_b32 s8, s56
    s_mov_b32 s9, s57
    s_mov_b32 s10, 0x400000
    s_mov_b32 s11, 0x20000
    s_add_u32 m0, s34, 0
    s_mov_b32 s28, 0
    buffer_load_dwordx4 v40, s[8:11], s28 offen lds
    s_add_u32 m0, s34, 1024
    s_mov_b32 s28, 131072
    buffer_load_dwordx4 v40, s[8:11], s28 offen lds
    s_add_u32 m0, s34, 2048
    s_mov_b32 s28, 262144
    buffer_load_dwordx4 v40, s[8:11], s28 offen lds
    s_add_u32 m0, s34, 3072
    s_mov_b32 s28, 393216
    buffer_load_dwordx4 v40, s[8:11], s28 offen lds
    s_add_u32 m0, s34, 4096
    s_mov_b32 s28, 524288
    buffer_load_dwordx4 v40, s[8:11], s28 offen lds
    s_add_u32 m0, s34, 5120
    s_mov_b32 s28, 655360
    buffer_load_dwordx4 v40, s[8:11], s28 offen lds
    s_add_u32 m0, s34, 6144
    s_mov_b32 s28, 786432
    buffer_load_dwordx4 v40, s[8:11], s28 offen lds
    s_add_u32 m0, s34, 7168
    s_mov_b32 s28, 917504
    buffer_load_dwordx4 v40, s[8:11], s28 offen lds
    s_add_u32 m0, s34, 8192
    s_mov_b32 s28, 1048576
    buffer_load_dwordx4 v40, s[8:11], s28 offen lds
    s_add_u32 m0, s34, 9216
    s_mov_b32 s28, 1179648
    buffer_load_dwordx4 v40, s[8:11], s28 offen lds
    s_add_u32 m0, s34, 10240
    s_mov_b32 s28, 1310720
    buffer_load_dwordx4 v40, s[8:11], s28 offen lds
    s_add_u32 m0, s34, 11264
    s_mov_b32 s28, 1441792
    buffer_load_dwordx4 v40, s[8:11], s28 offen lds
    s_add_u32 m0, s34, 12288
    s_mov_b32 s28, 1572864
    buffer_load_dwordx4 v40, s[8:11], s28 offen lds
    s_add_u32 m0, s34, 13312
    s_mov_b32 s28, 1703936
    buffer_load_dwordx4 v40, s[8:11], s28 offen lds
    s_add_u32 m0, s34, 14336
    s_mov_b32 s28, 1835008
    buffer_load_dwordx4 v40, s[8:11], s28 offen lds
    s_add_u32 m0, s34, 15360
    s_mov_b32 s28, 1966080
    buffer_load_dwordx4 v40, s[8:11], s28 offen lds
    s_add_u32 m0, s34, 16384
    s_mov_b32 s28, 2097152
    buffer_load_dwordx4 v40, s[8:11], s28 offen lds
    s_add_u32 m0, s34, 17408
    s_mov_b32 s28, 2228224
    buffer_load_dwordx4 v40, s[8:11], s28 offen lds
    s_add_u32 m0, s34, 18432
    s_mov_b32 s28, 2359296
    buffer_load_dwordx4 v40, s[8:11], s28 offen lds
    s_add_u32 m0, s34, 19456
    s_mov_b32 s28, 2490368
    buffer_load_dwordx4 v40, s[8:11], s28 offen lds
    s_add_u32 m0, s34, 20480
    s_mov_b32 s28, 2621440
    buffer_load_dwordx4 v40, s[8:11], s28 offen lds
    s_add_u32 m0, s34, 21504
    s_mov_b32 s28, 2752512
    buffer_load_dwordx4 v40, s[8:11], s28 offen lds
    s_add_u32 m0, s34, 22528
    s_mov_b32 s28, 2883584
    buffer_load_dwordx4 v40, s[8:11], s28 offen lds
    s_add_u32 m0, s34, 23552
    s_mov_b32 s28, 3014656
    buffer_load_dwordx4 v40, s[8:11], s28 offen lds
    s_add_u32 m0, s34, 24576
    s_mov_b32 s28, 3145728
    buffer_load_dwordx4 v40, s[8:11], s28 offen lds
    s_add_u32 m0, s34, 25600
    s_mov_b32 s28, 3276800
    buffer_load_dwordx4 v40, s[8:11], s28 offen lds
    s_add_u32 m0, s34, 26624
    s_mov_b32 s28, 3407872
    buffer_load_dwordx4 v40, s[8:11], s28 offen lds
    s_add_u32 m0, s34, 27648
    s_mov_b32 s28, 3538944
    buffer_load_dwordx4 v40, s[8:11], s28 offen lds
    s_add_u32 m0, s34, 28672
    s_mov_b32 s28, 3670016
    buffer_load_dwordx4 v40, s[8:11], s28 offen lds
    s_add_u32 m0, s34, 29696
    s_mov_b32 s28, 3801088
    buffer_load_dwordx4 v40, s[8:11], s28 offen lds
    s_add_u32 m0, s34, 30720
    s_mov_b32 s28, 3932160
    buffer_load_dwordx4 v40, s[8:11], s28 offen lds
    s_add_u32 m0, s34, 31744
    s_mov_b32 s28, 4063232
    buffer_load_dwordx4 v40, s[8:11], s28 offen lds
    s_waitcnt vmcnt(28)
    ds_read_b64_tr_b16 a[0:1], v43 offset:0
    ds_read_b64_tr_b16 a[2:3], v43 offset:256
    ds_read_b64_tr_b16 a[4:5], v43 offset:2048
    ds_read_b64_tr_b16 a[6:7], v43 offset:2304
    ds_read_b64_tr_b16 a[64:65], v44 offset:0
    ds_read_b64_tr_b16 a[66:67], v44 offset:256
    ds_read_b64_tr_b16 a[68:69], v44 offset:2048
    ds_read_b64_tr_b16 a[70:71], v44 offset:2304
    s_waitcnt lgkmcnt(0)
    s_mov_b32 s8, s62
    s_mov_b32 s9, s63
    s_mov_b32 s10, 0x400000
    s_mov_b32 s11, 0x20000
    s_add_u32 m0, s34, 0
    s_add_u32 s28, s35, 0
    buffer_load_dwordx4 v41, s[8:11], s28 offen lds
    s_add_u32 m0, s34, 1024
    s_add_u32 s28, s35, 4096
    buffer_load_dwordx4 v41, s[8:11], s28 offen lds
    s_add_u32 m0, s34, 2048
    s_add_u32 s28, s35, 8192
    buffer_load_dwordx4 v41, s[8:11], s28 offen lds
    s_add_u32 m0, s34, 3072
    s_add_u32 s28, s35, 12288
    buffer_load_dwordx4 v41, s[8:11], s28 offen lds
    s_waitcnt vmcnt(28)
    ds_read_b64_tr_b16 a[8:9], v43 offset:4096
    ds_read_b64_tr_b16 a[10:11], v43 offset:4352
    ds_read_b64_tr_b16 a[12:13], v43 offset:6144
    ds_read_b64_tr_b16 a[14:15], v43 offset:6400
    ds_read_b64_tr_b16 a[72:73], v44 offset:4096
    ds_read_b64_tr_b16 a[74:75], v44 offset:4352
    ds_read_b64_tr_b16 a[76:77], v44 offset:6144
    ds_read_b64_tr_b16 a[78:79], v44 offset:6400
    s_waitcnt lgkmcnt(0)
    s_add_u32 m0, s34, 4096
    s_add_u32 s28, s35, 16384
    buffer_load_dwordx4 v41, s[8:11], s28 offen lds
    s_add_u32 m0, s34, 5120
    s_add_u32 s28, s35, 20480
    buffer_load_dwordx4 v41, s[8:11], s28 offen lds
    s_add_u32 m0, s34, 6144
    s_add_u32 s28, s35, 24576
    buffer_load_dwordx4 v41, s[8:11], s28 offen lds
    s_add_u32 m0, s34, 7168
    s_add_u32 s28, s35, 28672
    buffer_load_dwordx4 v41, s[8:11], s28 offen lds
    s_waitcnt vmcnt(28)
    ds_read_b64_tr_b16 a[16:17], v43 offset:8192
    ds_read_b64_tr_b16 a[18:19], v43 offset:8448
    ds_read_b64_tr_b16 a[20:21], v43 offset:10240
    ds_read_b64_tr_b16 a[22:23], v43 offset:10496
    ds_read_b64_tr_b16 a[80:81], v44 offset:8192
    ds_read_b64_tr_b16 a[82:83], v44 offset:8448
    ds_read_b64_tr_b16 a[84:85], v44 offset:10240
    ds_read_b64_tr_b16 a[86:87], v44 offset:10496
    s_waitcnt lgkmcnt(0)
    s_add_u32 m0, s34, 8192
    s_add_u32 s28, s35, 32768
    buffer_load_dwordx4 v41, s[8:11], s28 offen lds
    s_add_u32 m0, s34, 9216
    s_add_u32 s28, s35, 36864
    buffer_load_dwordx4 v41, s[8:11], s28 offen lds
    s_add_u32 m0, s34, 10240
    s_add_u32 s28, s35, 40960
    buffer_load_dwordx4 v41, s[8:11], s28 offen lds
    s_add_u32 m0, s34, 11264
    s_add_u32 s28, s35, 45056
    buffer_load_dwordx4 v41, s[8:11], s28 offen lds
    s_waitcnt vmcnt(28)
    ds_read_b64_tr_b16 a[24:25], v43 offset:12288
    ds_read_b64_tr_b16 a[26:27], v43 offset:12544
    ds_read_b64_tr_b16 a[28:29], v43 offset:14336
    ds_read_b64_tr_b16 a[30:31], v43 offset:14592
    ds_read_b64_tr_b16 a[88:89], v44 offset:12288
    ds_read_b64_tr_b16 a[90:91], v44 offset:12544
    ds_read_b64_tr_b16 a[92:93], v44 offset:14336
    ds_read_b64_tr_b16 a[94:95], v44 offset:14592
    s_waitcnt lgkmcnt(0)
    s_add_u32 m0, s34, 12288
    s_add_u32 s28, s35, 49152
    buffer_load_dwordx4 v41, s[8:11], s28 offen lds
    s_add_u32 m0, s34, 13312
    s_add_u32 s28, s35, 53248
    buffer_load_dwordx4 v41, s[8:11], s28 offen lds
    s_add_u32 m0, s34, 14336
    s_add_u32 s28, s35, 57344
    buffer_load_dwordx4 v41, s[8:11], s28 offen lds
    s_add_u32 m0, s34, 15360
    s_add_u32 s28, s35, 61440
    buffer_load_dwordx4 v41, s[8:11], s28 offen lds
    s_waitcnt vmcnt(28)
    ds_read_b64_tr_b16 a[32:33], v43 offset:16384
    ds_read_b64_tr_b16 a[34:35], v43 offset:16640
    ds_read_b64_tr_b16 a[36:37], v43 offset:18432
    ds_read_b64_tr_b16 a[38:39], v43 offset:18688
    ds_read_b64_tr_b16 a[96:97], v44 offset:16384
    ds_read_b64_tr_b16 a[98:99], v44 offset:16640
    ds_read_b64_tr_b16 a[100:101], v44 offset:18432
    ds_read_b64_tr_b16 a[102:103], v44 offset:18688
    s_waitcnt lgkmcnt(0)
    s_add_u32 m0, s34, 16384
    s_add_u32 s28, s35, 65536
    buffer_load_dwordx4 v41, s[8:11], s28 offen lds
    s_add_u32 m0, s34, 17408
    s_add_u32 s28, s35, 69632
    buffer_load_dwordx4 v41, s[8:11], s28 offen lds
    s_add_u32 m0, s34, 18432
    s_add_u32 s28, s35, 73728
    buffer_load_dwordx4 v41, s[8:11], s28 offen lds
    s_add_u32 m0, s34, 19456
    s_add_u32 s28, s35, 77824
    buffer_load_dwordx4 v41, s[8:11], s28 offen lds
    s_waitcnt vmcnt(28)
    ds_read_b64_tr_b16 a[40:41], v43 offset:20480
    ds_read_b64_tr_b16 a[42:43], v43 offset:20736
    ds_read_b64_tr_b16 a[44:45], v43 offset:22528
    ds_read_b64_tr_b16 a[46:47], v43 offset:22784
    ds_read_b64_tr_b16 a[104:105], v44 offset:20480
    ds_read_b64_tr_b16 a[106:107], v44 offset:20736
    ds_read_b64_tr_b16 a[108:109], v44 offset:22528
    ds_read_b64_tr_b16 a[110:111], v44 offset:22784
    s_waitcnt lgkmcnt(0)
    s_add_u32 m0, s34, 20480
    s_add_u32 s28, s35, 81920
    buffer_load_dwordx4 v41, s[8:11], s28 offen lds
    s_add_u32 m0, s34, 21504
    s_add_u32 s28, s35, 86016
    buffer_load_dwordx4 v41, s[8:11], s28 offen lds
    s_add_u32 m0, s34, 22528
    s_add_u32 s28, s35, 90112
    buffer_load_dwordx4 v41, s[8:11], s28 offen lds
    s_add_u32 m0, s34, 23552
    s_add_u32 s28, s35, 94208
    buffer_load_dwordx4 v41, s[8:11], s28 offen lds
    s_waitcnt vmcnt(28)
    ds_read_b64_tr_b16 a[48:49], v43 offset:24576
    ds_read_b64_tr_b16 a[50:51], v43 offset:24832
    ds_read_b64_tr_b16 a[52:53], v43 offset:26624
    ds_read_b64_tr_b16 a[54:55], v43 offset:26880
    ds_read_b64_tr_b16 a[112:113], v44 offset:24576
    ds_read_b64_tr_b16 a[114:115], v44 offset:24832
    ds_read_b64_tr_b16 a[116:117], v44 offset:26624
    ds_read_b64_tr_b16 a[118:119], v44 offset:26880
    s_waitcnt lgkmcnt(0)
    s_add_u32 m0, s34, 24576
    s_add_u32 s28, s35, 98304
    buffer_load_dwordx4 v41, s[8:11], s28 offen lds
    s_add_u32 m0, s34, 25600
    s_add_u32 s28, s35, 102400
    buffer_load_dwordx4 v41, s[8:11], s28 offen lds
    s_add_u32 m0, s34, 26624
    s_add_u32 s28, s35, 106496
    buffer_load_dwordx4 v41, s[8:11], s28 offen lds
    s_add_u32 m0, s34, 27648
    s_add_u32 s28, s35, 110592
    buffer_load_dwordx4 v41, s[8:11], s28 offen lds
    s_waitcnt vmcnt(28)
    ds_read_b64_tr_b16 a[56:57], v43 offset:28672
    ds_read_b64_tr_b16 a[58:59], v43 offset:28928
    ds_read_b64_tr_b16 a[60:61], v43 offset:30720
    ds_read_b64_tr_b16 a[62:63], v43 offset:30976
    ds_read_b64_tr_b16 a[120:121], v44 offset:28672
    ds_read_b64_tr_b16 a[122:123], v44 offset:28928
    ds_read_b64_tr_b16 a[124:125], v44 offset:30720
    ds_read_b64_tr_b16 a[126:127], v44 offset:30976
    s_waitcnt lgkmcnt(0)
    s_add_u32 m0, s34, 28672
    s_add_u32 s28, s35, 114688
    buffer_load_dwordx4 v41, s[8:11], s28 offen lds
    s_add_u32 m0, s34, 29696
    s_add_u32 s28, s35, 118784
    buffer_load_dwordx4 v41, s[8:11], s28 offen lds
    s_add_u32 m0, s34, 30720
    s_add_u32 s28, s35, 122880
    buffer_load_dwordx4 v41, s[8:11], s28 offen lds
    s_add_u32 m0, s34, 31744
    s_add_u32 s28, s35, 126976
    buffer_load_dwordx4 v41, s[8:11], s28 offen lds
    s_waitcnt vmcnt(28)
    ds_read_b64_tr_b16 v[128:129], v45 offset:0
    ds_read_b64_tr_b16 v[144:145], v45 offset:8
    ds_read_b64_tr_b16 v[160:161], v46 offset:0
    ds_read_b64_tr_b16 v[176:177], v46 offset:8
    ds_read_b64_tr_b16 v[192:193], v47 offset:0
    ds_read_b64_tr_b16 v[208:209], v47 offset:8
    ds_read_b64_tr_b16 v[224:225], v48 offset:0
    ds_read_b64_tr_b16 v[240:241], v48 offset:8
    s_waitcnt lgkmcnt(0)
    s_waitcnt vmcnt(24)
    ds_read_b64_tr_b16 v[130:131], v45 offset:4096
    ds_read_b64_tr_b16 v[146:147], v45 offset:4104
    ds_read_b64_tr_b16 v[162:163], v46 offset:4096
    ds_read_b64_tr_b16 v[178:179], v46 offset:4104
    ds_read_b64_tr_b16 v[194:195], v47 offset:4096
    ds_read_b64_tr_b16 v[210:211], v47 offset:4104
    ds_read_b64_tr_b16 v[226:227], v48 offset:4096
    ds_read_b64_tr_b16 v[242:243], v48 offset:4104
    s_waitcnt lgkmcnt(0)
    s_waitcnt vmcnt(20)
    ds_read_b64_tr_b16 v[132:133], v45 offset:8192
    ds_read_b64_tr_b16 v[148:149], v45 offset:8200
    ds_read_b64_tr_b16 v[164:165], v46 offset:8192
    ds_read_b64_tr_b16 v[180:181], v46 offset:8200
    ds_read_b64_tr_b16 v[196:197], v47 offset:8192
    ds_read_b64_tr_b16 v[212:213], v47 offset:8200
    ds_read_b64_tr_b16 v[228:229], v48 offset:8192
    ds_read_b64_tr_b16 v[244:245], v48 offset:8200
    s_waitcnt lgkmcnt(0)
    s_waitcnt vmcnt(16)
    ds_read_b64_tr_b16 v[134:135], v45 offset:12288
    ds_read_b64_tr_b16 v[150:151], v45 offset:12296
    ds_read_b64_tr_b16 v[166:167], v46 offset:12288
    ds_read_b64_tr_b16 v[182:183], v46 offset:12296
    ds_read_b64_tr_b16 v[198:199], v47 offset:12288
    ds_read_b64_tr_b16 v[214:215], v47 offset:12296
    ds_read_b64_tr_b16 v[230:231], v48 offset:12288
    ds_read_b64_tr_b16 v[246:247], v48 offset:12296
    s_waitcnt lgkmcnt(0)
    s_waitcnt vmcnt(12)
    ds_read_b64_tr_b16 v[136:137], v45 offset:16384
    ds_read_b64_tr_b16 v[152:153], v45 offset:16392
    ds_read_b64_tr_b16 v[168:169], v46 offset:16384
    ds_read_b64_tr_b16 v[184:185], v46 offset:16392
    ds_read_b64_tr_b16 v[200:201], v47 offset:16384
    ds_read_b64_tr_b16 v[216:217], v47 offset:16392
    ds_read_b64_tr_b16 v[232:233], v48 offset:16384
    ds_read_b64_tr_b16 v[248:249], v48 offset:16392
    s_waitcnt lgkmcnt(0)
    s_waitcnt vmcnt(8)
    ds_read_b64_tr_b16 v[138:139], v45 offset:20480
    ds_read_b64_tr_b16 v[154:155], v45 offset:20488
    ds_read_b64_tr_b16 v[170:171], v46 offset:20480
    ds_read_b64_tr_b16 v[186:187], v46 offset:20488
    ds_read_b64_tr_b16 v[202:203], v47 offset:20480
    ds_read_b64_tr_b16 v[218:219], v47 offset:20488
    ds_read_b64_tr_b16 v[234:235], v48 offset:20480
    ds_read_b64_tr_b16 v[250:251], v48 offset:20488
    s_waitcnt lgkmcnt(0)
    s_waitcnt vmcnt(4)
    ds_read_b64_tr_b16 v[140:141], v45 offset:24576
    ds_read_b64_tr_b16 v[156:157], v45 offset:24584
    ds_read_b64_tr_b16 v[172:173], v46 offset:24576
    ds_read_b64_tr_b16 v[188:189], v46 offset:24584
    ds_read_b64_tr_b16 v[204:205], v47 offset:24576
    ds_read_b64_tr_b16 v[220:221], v47 offset:24584
    ds_read_b64_tr_b16 v[236:237], v48 offset:24576
    ds_read_b64_tr_b16 v[252:253], v48 offset:24584
    s_waitcnt lgkmcnt(0)
    s_waitcnt vmcnt(0)
    ds_read_b64_tr_b16 v[142:143], v45 offset:28672
    ds_read_b64_tr_b16 v[158:159], v45 offset:28680
    ds_read_b64_tr_b16 v[174:175], v46 offset:28672
    ds_read_b64_tr_b16 v[190:191], v46 offset:28680
    ds_read_b64_tr_b16 v[206:207], v47 offset:28672
    ds_read_b64_tr_b16 v[222:223], v47 offset:28680
    ds_read_b64_tr_b16 v[238:239], v48 offset:28672
    ds_read_b64_tr_b16 v[254:255], v48 offset:28680
    s_waitcnt lgkmcnt(0)
    s_barrier
    s_cmp_lt_u32 s23, 2
    s_cbranch_scc1 L_cv_skip_24
    s_cmp_gt_u32 s23, 5
    s_cbranch_scc1 L_cv_skip_24
    s_sub_u32 s44, s23, 2
    s_lshl_b32 s44, s44, 5
    s_add_u32 s44, s44, s22
    s_lshl_b32 s45, s44, 2
    s_add_u32 s45, s45, s21
    s_load_dwordx4 s[64:67], s[0:1], 0
    s_load_dwordx4 s[68:71], s[0:1], 16
    s_load_dwordx4 s[72:75], s[0:1], 32
    s_load_dwordx2 s[76:77], s[0:1], 104
    s_waitcnt lgkmcnt(0)
    s_lshl_b32 s28, s44, 5
    s_add_u32 s70, s70, s28
    s_addc_u32 s71, s71, 0
    s_lshl_b32 s28, s44, 3
    s_add_u32 s74, s74, s28
    s_addc_u32 s75, s75, 0
    s_load_dwordx8 s[80:87], s[70:71], 0
    s_load_dwordx2 s[88:89], s[74:75], 0
    v_lshrrev_b32 v2, 4, v0
    s_mov_b32 s8, s72
    s_mov_b32 s9, s73
    s_mov_b32 s10, 0x200000
    s_mov_b32 s11, 0x20000
    s_mul_i32 s32, s21, 17664
    s_lshl_b32 s33, s45, 12
    s_add_u32 m0, s32, 64
    s_add_u32 s28, s33, 0
    buffer_load_dwordx4 v0, s[8:11], s28 offen lds
    s_add_u32 m0, s32, 1088
    s_add_u32 s28, s33, 1024
    buffer_load_dwordx4 v0, s[8:11], s28 offen lds
    s_add_u32 m0, s32, 2112
    s_add_u32 s28, s33, 2048
    buffer_load_dwordx4 v0, s[8:11], s28 offen lds
    s_add_u32 m0, s32, 3136
    s_add_u32 s28, s33, 3072
    buffer_load_dwordx4 v0, s[8:11], s28 offen lds
    s_add_u32 m0, s32, 4480
    s_add_u32 s28, s33, 2
    buffer_load_dwordx4 v0, s[8:11], s28 offen lds
    s_add_u32 m0, s32, 5504
    s_add_u32 s28, s33, 1026
    buffer_load_dwordx4 v0, s[8:11], s28 offen lds
    s_add_u32 m0, s32, 6528
    s_add_u32 s28, s33, 2050
    buffer_load_dwordx4 v0, s[8:11], s28 offen lds
    s_add_u32 m0, s32, 7552
    s_add_u32 s28, s33, 3074
    buffer_load_dwordx4 v0, s[8:11], s28 offen lds
    s_add_u32 m0, s32, 8896
    s_add_u32 s28, s33, 4
    buffer_load_dwordx4 v0, s[8:11], s28 offen lds
    s_add_u32 m0, s32, 9920
    s_add_u32 s28, s33, 1028
    buffer_load_dwordx4 v0, s[8:11], s28 offen lds
    s_add_u32 m0, s32, 10944
    s_add_u32 s28, s33, 2052
    buffer_load_dwordx4 v0, s[8:11], s28 offen lds
    s_add_u32 m0, s32, 11968
    s_add_u32 s28, s33, 3076
    buffer_load_dwordx4 v0, s[8:11], s28 offen lds
    s_add_u32 m0, s32, 13312
    s_add_u32 s28, s33, 6
    buffer_load_dwordx4 v0, s[8:11], s28 offen lds
    s_add_u32 m0, s32, 14336
    s_add_u32 s28, s33, 1030
    buffer_load_dwordx4 v0, s[8:11], s28 offen lds
    s_add_u32 m0, s32, 15360
    s_add_u32 s28, s33, 2054
    buffer_load_dwordx4 v0, s[8:11], s28 offen lds
    s_add_u32 m0, s32, 16384
    s_add_u32 s28, s33, 3078
    buffer_load_dwordx4 v0, s[8:11], s28 offen lds
    v_mov_b32 v4, 0
    v_mov_b32 v5, 0
    v_mov_b32 v6, 0
    v_mov_b32 v7, 0
    v_bfe_u32 v8, v2, 2, 2
    v_mul_u32_u24 v8, 4416, v8
    v_and_b32 v9, 3, v2
    v_lshlrev_b32 v9, 4, v9
    v_add_u32 v8, v8, v9
    v_add_u32 v8, s32, v8
    ds_write_b128 v8, v[4:7]
    v_and_b32 v9, 3, v2
    v_lshlrev_b32 v10, 1, v9
    v_add_u32 v10, s33, v10
    buffer_load_ushort v11, v10, s[8:11], 0 offen
    v_bfe_u32 v12, v2, 2, 2
    v_mul_u32_u24 v13, 4414, v12
    v_lshlrev_b32 v14, 1, v9
    v_add_u32 v13, v13, v14
    v_add_u32 v13, 64, v13
    v_add_u32 v13, s32, v13
    v_cmp_lt_u32 vcc, v9, v12
    v_cmp_gt_u32 s[30:31], 16, v2
    s_nop 1
    s_and_b64 s[30:31], s[30:31], vcc
    s_mul_i32 s28, s21, 7680
    s_add_u32 s28, s28, 70656
    v_add_u32 v8, s28, v0
    ds_write_b128 v8, v[4:7]
    ds_write_b128 v8, v[4:7] offset:1024
    v_cmp_gt_u32 vcc, 32, v2
    s_nop 1
    s_mov_b64 exec, vcc
    ds_write_b128 v8, v[4:7] offset:2048
    s_mov_b64 exec, s[26:27]
    s_waitcnt vmcnt(0)
    s_mov_b64 exec, s[30:31]
    ds_write_b16 v13, v11
    s_mov_b64 exec, s[26:27]
    s_mov_b32 s8, s66
    s_mov_b32 s9, s67
    s_mov_b32 s10, 0x200000
    s_mov_b32 s11, 0x20000
    s_mov_b32 s12, s68
    s_mov_b32 s13, s69
    s_mov_b32 s14, 0x200000
    s_mov_b32 s15, 0x20000
    s_lshl_b32 s28, s21, 6
    v_add_u32 v3, s28, v2
    v_lshlrev_b32 v4, 13, v3
    s_lshl_b32 s28, s44, 3
    v_add_u32 v4, s28, v4
    v_add_u32 v5, 4294964224, v4
    buffer_load_dwordx2 v[16:17], v5, s[8:11], 0 offen
    v_add_u32 v5, 4294965248, v4
    buffer_load_dwordx2 v[18:19], v5, s[8:11], 0 offen
    v_add_u32 v5, 4294966272, v4
    buffer_load_dwordx2 v[20:21], v5, s[8:11], 0 offen
    v_add_u32 v5, 0, v4
    buffer_load_dwordx2 v[22:23], v5, s[8:11], 0 offen
    v_add_u32 v5, 1024, v4
    buffer_load_dwordx2 v[24:25], v5, s[8:11], 0 offen
    v_add_u32 v5, 2048, v4
    buffer_load_dwordx2 v[26:27], v5, s[8:11], 0 offen
    v_add_u32 v5, 3072, v4
    buffer_load_dwordx2 v[28:29], v5, s[8:11], 0 offen
    v_add_u32 v5, 4096, v4
    buffer_load_dwordx2 v[30:31], v5, s[8:11], 0 offen
    v_add_u32 v5, 5120, v4
    buffer_load_dwordx2 v[32:33], v5, s[8:11], 0 offen
    v_add_u32 v5, 6144, v4
    buffer_load_dwordx2 v[34:35], v5, s[8:11], 0 offen
    v_add_u32 v5, 7168, v4
    buffer_load_dwordx2 v[36:37], v5, s[8:11], 0 offen
    v_add_u32 v5, 0, v4
    buffer_load_dwordx2 v[40:41], v5, s[12:15], 0 offen
    v_add_u32 v5, 1024, v4
    buffer_load_dwordx2 v[42:43], v5, s[12:15], 0 offen
    v_add_u32 v5, 2048, v4
    buffer_load_dwordx2 v[44:45], v5, s[12:15], 0 offen
    v_add_u32 v5, 3072, v4
    buffer_load_dwordx2 v[46:47], v5, s[12:15], 0 offen
    v_add_u32 v5, 4096, v4
    buffer_load_dwordx2 v[48:49], v5, s[12:15], 0 offen
    v_add_u32 v5, 5120, v4
    buffer_load_dwordx2 v[50:51], v5, s[12:15], 0 offen
    v_add_u32 v5, 6144, v4
    buffer_load_dwordx2 v[52:53], v5, s[12:15], 0 offen
    v_add_u32 v5, 7168, v4
    buffer_load_dwordx2 v[54:55], v5, s[12:15], 0 offen
    s_waitcnt lgkmcnt(0)
    s_lshl_b32 s28, s80, 16
    v_mov_b32 v96, s28
    s_and_b32 s28, s80, 0xffff0000
    v_mov_b32 v97, s28
    s_lshl_b32 s28, s81, 16
    v_mov_b32 v98, s28
    s_and_b32 s28, s81, 0xffff0000
    v_mov_b32 v99, s28
    s_lshl_b32 s28, s82, 16
    v_mov_b32 v100, s28
    s_and_b32 s28, s82, 0xffff0000
    v_mov_b32 v101, s28
    s_lshl_b32 s28, s83, 16
    v_mov_b32 v102, s28
    s_and_b32 s28, s83, 0xffff0000
    v_mov_b32 v103, s28
    s_lshl_b32 s28, s84, 16
    v_mov_b32 v104, s28
    s_and_b32 s28, s84, 0xffff0000
    v_mov_b32 v105, s28
    s_lshl_b32 s28, s85, 16
    v_mov_b32 v106, s28
    s_and_b32 s28, s85, 0xffff0000
    v_mov_b32 v107, s28
    s_lshl_b32 s28, s86, 16
    v_mov_b32 v108, s28
    s_and_b32 s28, s86, 0xffff0000
    v_mov_b32 v109, s28
    s_lshl_b32 s28, s87, 16
    v_mov_b32 v110, s28
    s_and_b32 s28, s87, 0xffff0000
    v_mov_b32 v111, s28
    s_lshl_b32 s28, s88, 16
    v_mov_b32 v112, s28
    s_and_b32 s28, s88, 0xffff0000
    v_mov_b32 v113, s28
    s_lshl_b32 s28, s89, 16
    v_mov_b32 v114, s28
    s_and_b32 s28, s89, 0xffff0000
    v_mov_b32 v115, s28
    s_waitcnt vmcnt(0)
    v_lshlrev_b32 v72, 16, v16
    v_lshlrev_b32 v73, 16, v18
    v_lshlrev_b32 v74, 16, v20
    v_lshlrev_b32 v75, 16, v22
    v_lshlrev_b32 v76, 16, v24
    v_lshlrev_b32 v77, 16, v26
    v_lshlrev_b32 v78, 16, v28
    v_lshlrev_b32 v79, 16, v30
    v_lshlrev_b32 v80, 16, v32
    v_lshlrev_b32 v81, 16, v34
    v_lshlrev_b32 v82, 16, v36
    v_mul_f32 v84, v72, v99
    v_fmac_f32 v84, v73, v98
    v_fmac_f32 v84, v74, v97
    v_fmac_f32 v84, v75, v96
    v_lshlrev_b32 v92, 16, v40
    v_mul_f32 v84, v84, v92
    v_mul_f32 v85, v73, v99
    v_fmac_f32 v85, v74, v98
    v_fmac_f32 v85, v75, v97
    v_fmac_f32 v85, v76, v96
    v_lshlrev_b32 v92, 16, v42
    v_mul_f32 v85, v85, v92
    v_mul_f32 v86, v74, v99
    v_fmac_f32 v86, v75, v98
    v_fmac_f32 v86, v76, v97
    v_fmac_f32 v86, v77, v96
    v_lshlrev_b32 v92, 16, v44
    v_mul_f32 v86, v86, v92
    v_mul_f32 v87, v75, v99
    v_fmac_f32 v87, v76, v98
    v_fmac_f32 v87, v77, v97
    v_fmac_f32 v87, v78, v96
    v_lshlrev_b32 v92, 16, v46
    v_mul_f32 v87, v87, v92
    v_mul_f32 v88, v76, v99
    v_fmac_f32 v88, v77, v98
    v_fmac_f32 v88, v78, v97
    v_fmac_f32 v88, v79, v96
    v_lshlrev_b32 v92, 16, v48
    v_mul_f32 v88, v88, v92
    v_mul_f32 v89, v77, v99
    v_fmac_f32 v89, v78, v98
    v_fmac_f32 v89, v79, v97
    v_fmac_f32 v89, v80, v96
    v_lshlrev_b32 v92, 16, v50
    v_mul_f32 v89, v89, v92
    v_mul_f32 v90, v78, v99
    v_fmac_f32 v90, v79, v98
    v_fmac_f32 v90, v80, v97
    v_fmac_f32 v90, v81, v96
    v_lshlrev_b32 v92, 16, v52
    v_mul_f32 v90, v90, v92
    v_mul_f32 v91, v79, v99
    v_fmac_f32 v91, v80, v98
    v_fmac_f32 v91, v81, v97
    v_fmac_f32 v91, v82, v96
    v_lshlrev_b32 v92, 16, v54
    v_mul_f32 v91, v91, v92
    v_cvt_pk_bf16_f32 v56, v91, v90
    v_cvt_pk_bf16_f32 v57, v89, v88
    v_cvt_pk_bf16_f32 v58, v87, v86
    v_cvt_pk_bf16_f32 v59, v85, v84
    v_and_b32 v72, 0xffff0000, v16
    v_and_b32 v73, 0xffff0000, v18
    v_and_b32 v74, 0xffff0000, v20
    v_and_b32 v75, 0xffff0000, v22
    v_and_b32 v76, 0xffff0000, v24
    v_and_b32 v77, 0xffff0000, v26
    v_and_b32 v78, 0xffff0000, v28
    v_and_b32 v79, 0xffff0000, v30
    v_and_b32 v80, 0xffff0000, v32
    v_and_b32 v81, 0xffff0000, v34
    v_and_b32 v82, 0xffff0000, v36
    v_mul_f32 v84, v72, v103
    v_fmac_f32 v84, v73, v102
    v_fmac_f32 v84, v74, v101
    v_fmac_f32 v84, v75, v100
    v_and_b32 v92, 0xffff0000, v40
    v_mul_f32 v84, v84, v92
    v_mul_f32 v85, v73, v103
    v_fmac_f32 v85, v74, v102
    v_fmac_f32 v85, v75, v101
    v_fmac_f32 v85, v76, v100
    v_and_b32 v92, 0xffff0000, v42
    v_mul_f32 v85, v85, v92
    v_mul_f32 v86, v74, v103
    v_fmac_f32 v86, v75, v102
    v_fmac_f32 v86, v76, v101
    v_fmac_f32 v86, v77, v100
    v_and_b32 v92, 0xffff0000, v44
    v_mul_f32 v86, v86, v92
    v_mul_f32 v87, v75, v103
    v_fmac_f32 v87, v76, v102
    v_fmac_f32 v87, v77, v101
    v_fmac_f32 v87, v78, v100
    v_and_b32 v92, 0xffff0000, v46
    v_mul_f32 v87, v87, v92
    v_mul_f32 v88, v76, v103
    v_fmac_f32 v88, v77, v102
    v_fmac_f32 v88, v78, v101
    v_fmac_f32 v88, v79, v100
    v_and_b32 v92, 0xffff0000, v48
    v_mul_f32 v88, v88, v92
    v_mul_f32 v89, v77, v103
    v_fmac_f32 v89, v78, v102
    v_fmac_f32 v89, v79, v101
    v_fmac_f32 v89, v80, v100
    v_and_b32 v92, 0xffff0000, v50
    v_mul_f32 v89, v89, v92
    v_mul_f32 v90, v78, v103
    v_fmac_f32 v90, v79, v102
    v_fmac_f32 v90, v80, v101
    v_fmac_f32 v90, v81, v100
    v_and_b32 v92, 0xffff0000, v52
    v_mul_f32 v90, v90, v92
    v_mul_f32 v91, v79, v103
    v_fmac_f32 v91, v80, v102
    v_fmac_f32 v91, v81, v101
    v_fmac_f32 v91, v82, v100
    v_and_b32 v92, 0xffff0000, v54
    v_mul_f32 v91, v91, v92
    v_cvt_pk_bf16_f32 v60, v91, v90
    v_cvt_pk_bf16_f32 v61, v89, v88
    v_cvt_pk_bf16_f32 v62, v87, v86
    v_cvt_pk_bf16_f32 v63, v85, v84
    v_lshlrev_b32 v72, 16, v17
    v_lshlrev_b32 v73, 16, v19
    v_lshlrev_b32 v74, 16, v21
    v_lshlrev_b32 v75, 16, v23
    v_lshlrev_b32 v76, 16, v25
    v_lshlrev_b32 v77, 16, v27
    v_lshlrev_b32 v78, 16, v29
    v_lshlrev_b32 v79, 16, v31
    v_lshlrev_b32 v80, 16, v33
    v_lshlrev_b32 v81, 16, v35
    v_lshlrev_b32 v82, 16, v37
    v_mul_f32 v84, v72, v107
    v_fmac_f32 v84, v73, v106
    v_fmac_f32 v84, v74, v105
    v_fmac_f32 v84, v75, v104
    v_lshlrev_b32 v92, 16, v41
    v_mul_f32 v84, v84, v92
    v_mul_f32 v85, v73, v107
    v_fmac_f32 v85, v74, v106
    v_fmac_f32 v85, v75, v105
    v_fmac_f32 v85, v76, v104
    v_lshlrev_b32 v92, 16, v43
    v_mul_f32 v85, v85, v92
    v_mul_f32 v86, v74, v107
    v_fmac_f32 v86, v75, v106
    v_fmac_f32 v86, v76, v105
    v_fmac_f32 v86, v77, v104
    v_lshlrev_b32 v92, 16, v45
    v_mul_f32 v86, v86, v92
    v_mul_f32 v87, v75, v107
    v_fmac_f32 v87, v76, v106
    v_fmac_f32 v87, v77, v105
    v_fmac_f32 v87, v78, v104
    v_lshlrev_b32 v92, 16, v47
    v_mul_f32 v87, v87, v92
    v_mul_f32 v88, v76, v107
    v_fmac_f32 v88, v77, v106
    v_fmac_f32 v88, v78, v105
    v_fmac_f32 v88, v79, v104
    v_lshlrev_b32 v92, 16, v49
    v_mul_f32 v88, v88, v92
    v_mul_f32 v89, v77, v107
    v_fmac_f32 v89, v78, v106
    v_fmac_f32 v89, v79, v105
    v_fmac_f32 v89, v80, v104
    v_lshlrev_b32 v92, 16, v51
    v_mul_f32 v89, v89, v92
    v_mul_f32 v90, v78, v107
    v_fmac_f32 v90, v79, v106
    v_fmac_f32 v90, v80, v105
    v_fmac_f32 v90, v81, v104
    v_lshlrev_b32 v92, 16, v53
    v_mul_f32 v90, v90, v92
    v_mul_f32 v91, v79, v107
    v_fmac_f32 v91, v80, v106
    v_fmac_f32 v91, v81, v105
    v_fmac_f32 v91, v82, v104
    v_lshlrev_b32 v92, 16, v55
    v_mul_f32 v91, v91, v92
    v_cvt_pk_bf16_f32 v64, v91, v90
    v_cvt_pk_bf16_f32 v65, v89, v88
    v_cvt_pk_bf16_f32 v66, v87, v86
    v_cvt_pk_bf16_f32 v67, v85, v84
    v_and_b32 v72, 0xffff0000, v17
    v_and_b32 v73, 0xffff0000, v19
    v_and_b32 v74, 0xffff0000, v21
    v_and_b32 v75, 0xffff0000, v23
    v_and_b32 v76, 0xffff0000, v25
    v_and_b32 v77, 0xffff0000, v27
    v_and_b32 v78, 0xffff0000, v29
    v_and_b32 v79, 0xffff0000, v31
    v_and_b32 v80, 0xffff0000, v33
    v_and_b32 v81, 0xffff0000, v35
    v_and_b32 v82, 0xffff0000, v37
    v_mul_f32 v84, v72, v111
    v_fmac_f32 v84, v73, v110
    v_fmac_f32 v84, v74, v109
    v_fmac_f32 v84, v75, v108
    v_and_b32 v92, 0xffff0000, v41
    v_mul_f32 v84, v84, v92
    v_mul_f32 v85, v73, v111
    v_fmac_f32 v85, v74, v110
    v_fmac_f32 v85, v75, v109
    v_fmac_f32 v85, v76, v108
    v_and_b32 v92, 0xffff0000, v43
    v_mul_f32 v85, v85, v92
    v_mul_f32 v86, v74, v111
    v_fmac_f32 v86, v75, v110
    v_fmac_f32 v86, v76, v109
    v_fmac_f32 v86, v77, v108
    v_and_b32 v92, 0xffff0000, v45
    v_mul_f32 v86, v86, v92
    v_mul_f32 v87, v75, v111
    v_fmac_f32 v87, v76, v110
    v_fmac_f32 v87, v77, v109
    v_fmac_f32 v87, v78, v108
    v_and_b32 v92, 0xffff0000, v47
    v_mul_f32 v87, v87, v92
    v_mul_f32 v88, v76, v111
    v_fmac_f32 v88, v77, v110
    v_fmac_f32 v88, v78, v109
    v_fmac_f32 v88, v79, v108
    v_and_b32 v92, 0xffff0000, v49
    v_mul_f32 v88, v88, v92
    v_mul_f32 v89, v77, v111
    v_fmac_f32 v89, v78, v110
    v_fmac_f32 v89, v79, v109
    v_fmac_f32 v89, v80, v108
    v_and_b32 v92, 0xffff0000, v51
    v_mul_f32 v89, v89, v92
    v_mul_f32 v90, v78, v111
    v_fmac_f32 v90, v79, v110
    v_fmac_f32 v90, v80, v109
    v_fmac_f32 v90, v81, v108
    v_and_b32 v92, 0xffff0000, v53
    v_mul_f32 v90, v90, v92
    v_mul_f32 v91, v79, v111
    v_fmac_f32 v91, v80, v110
    v_fmac_f32 v91, v81, v109
    v_fmac_f32 v91, v82, v108
    v_and_b32 v92, 0xffff0000, v55
    v_mul_f32 v91, v91, v92
    v_cvt_pk_bf16_f32 v68, v91, v90
    v_cvt_pk_bf16_f32 v69, v89, v88
    v_cvt_pk_bf16_f32 v70, v87, v86
    v_cvt_pk_bf16_f32 v71, v85, v84
    v_lshrrev_b32 v4, 2, v3
    v_mul_u32_u24 v4, 80, v4
    v_and_b32 v5, 3, v3
    v_lshlrev_b32 v5, 4, v5
    v_add_u32 v4, v4, v5
    v_add_u32 v4, 73216, v4
    s_waitcnt lgkmcnt(0)
    s_barrier
    ds_write_b128 v4, v[56:59] offset:0
    ds_write_b128 v4, v[60:63] offset:7680
    ds_write_b128 v4, v[64:67] offset:15360
    ds_write_b128 v4, v[68:71] offset:23040
    s_mov_b32 s8, s64
    s_mov_b32 s9, s65
    s_mov_b32 s10, 0x200000
    s_mov_b32 s11, 0x20000
    v_lshlrev_b32 v4, 13, v3
    s_lshl_b32 s28, s44, 3
    v_add_u32 v4, s28, v4
    v_add_u32 v5, 0, v4
    buffer_load_dwordx2 v[16:17], v5, s[8:11], 0 offen
    v_add_u32 v5, 1024, v4
    buffer_load_dwordx2 v[18:19], v5, s[8:11], 0 offen
    v_add_u32 v5, 2048, v4
    buffer_load_dwordx2 v[20:21], v5, s[8:11], 0 offen
    v_add_u32 v5, 3072, v4
    buffer_load_dwordx2 v[22:23], v5, s[8:11], 0 offen
    v_add_u32 v5, 4096, v4
    buffer_load_dwordx2 v[24:25], v5, s[8:11], 0 offen
    v_add_u32 v5, 5120, v4
    buffer_load_dwordx2 v[26:27], v5, s[8:11], 0 offen
    v_add_u32 v5, 6144, v4
    buffer_load_dwordx2 v[28:29], v5, s[8:11], 0 offen
    v_add_u32 v5, 7168, v4
    buffer_load_dwordx2 v[30:31], v5, s[8:11], 0 offen
    s_waitcnt lgkmcnt(0)
    s_barrier
    v_and_b32 v6, 31, v2
    v_lshrrev_b32 v7, 5, v2
    v_add_u32 v8, 1, v6
    v_and_b32 v8, 3, v8
    v_mul_u32_u24 v8, 4416, v8
    v_lshlrev_b32 v9, 3, v7
    v_sub_u32 v9, v6, v9
    v_add_u32 v9, 25, v9
    v_lshrrev_b32 v9, 2, v9
    v_lshlrev_b32 v9, 3, v9
    v_add_u32 v8, v8, v9
    v_add_u32 v8, s32, v8
    v_subrev_u32 v8, 32, v8
    v_mul_u32_u24 v9, 80, v6
    v_lshlrev_b32 v10, 4, v7
    v_add_u32 v9, v9, v10
    s_mul_i32 s28, s21, 7680
    s_add_u32 s28, s28, 68176
    v_add_u32 v9, s28, v9
    ds_read_b64 v[72:73], v8 offset:32
    ds_read_b64 v[74:75], v8 offset:40
    ds_read_b128 v[88:91], v9 offset:7600
    ds_read_b128 v[92:95], v9 offset:5040
    ds_read_b64 v[76:77], v8 offset:0
    ds_read_b64 v[78:79], v8 offset:8
    ds_read_b128 v[96:99], v9 offset:7632
    ds_read_b128 v[100:103], v9 offset:5072
    s_waitcnt lgkmcnt(4)
    v_mfma_f32_32x32x16_bf16 a[144:159], v[72:75], v[88:91], 0
    v_mfma_f32_32x32x16_bf16 a[128:143], v[72:75], v[92:95], 0
    ds_read_b64 v[80:81], v8 offset:96
    ds_read_b64 v[82:83], v8 offset:104
    ds_read_b128 v[104:107], v9 offset:7520
    ds_read_b128 v[108:111], v9 offset:4960
    s_waitcnt lgkmcnt(4)
    v_mfma_f32_32x32x16_bf16 a[144:159], v[76:79], v[96:99], a[144:159]
    v_mfma_f32_32x32x16_bf16 a[128:143], v[76:79], v[100:103], a[128:143]
    ds_read_b64 v[84:85], v8 offset:64
    ds_read_b64 v[86:87], v8 offset:72
    ds_read_b128 v[88:91], v9 offset:7552
    ds_read_b128 v[92:95], v9 offset:4992
    s_waitcnt lgkmcnt(4)
    v_mfma_f32_32x32x16_bf16 a[144:159], v[80:83], v[104:107], a[144:159]
    v_mfma_f32_32x32x16_bf16 a[128:143], v[80:83], v[108:111], a[128:143]
    ds_read_b64 v[72:73], v8 offset:160
    ds_read_b64 v[74:75], v8 offset:168
    ds_read_b128 v[96:99], v9 offset:7440
    ds_read_b128 v[100:103], v9 offset:4880
    s_waitcnt lgkmcnt(4)
    v_mfma_f32_32x32x16_bf16 a[144:159], v[84:87], v[88:91], a[144:159]
    v_mfma_f32_32x32x16_bf16 a[128:143], v[84:87], v[92:95], a[128:143]
    ds_read_b64 v[76:77], v8 offset:128
    ds_read_b64 v[78:79], v8 offset:136
    ds_read_b128 v[104:107], v9 offset:7472
    ds_read_b128 v[108:111], v9 offset:4912
    s_waitcnt lgkmcnt(4)
    v_mfma_f32_32x32x16_bf16 a[144:159], v[72:75], v[96:99], a[144:159]
    v_mfma_f32_32x32x16_bf16 a[128:143], v[72:75], v[100:103], a[128:143]
    ds_read_b64 v[80:81], v8 offset:224
    ds_read_b64 v[82:83], v8 offset:232
    ds_read_b128 v[88:91], v9 offset:7360
    ds_read_b128 v[92:95], v9 offset:4800
    s_waitcnt lgkmcnt(4)
    v_mfma_f32_32x32x16_bf16 a[144:159], v[76:79], v[104:107], a[144:159]
    v_mfma_f32_32x32x16_bf16 a[128:143], v[76:79], v[108:111], a[128:143]
    ds_read_b64 v[84:85], v8 offset:192
    ds_read_b64 v[86:87], v8 offset:200
    ds_read_b128 v[96:99], v9 offset:7392
    ds_read_b128 v[100:103], v9 offset:4832
    s_waitcnt lgkmcnt(4)
    v_mfma_f32_32x32x16_bf16 a[144:159], v[80:83], v[88:91], a[144:159]
    v_mfma_f32_32x32x16_bf16 a[128:143], v[80:83], v[92:95], a[128:143]
    ds_read_b64 v[72:73], v8 offset:288
    ds_read_b64 v[74:75], v8 offset:296
    ds_read_b128 v[104:107], v9 offset:7280
    ds_read_b128 v[108:111], v9 offset:4720
    s_waitcnt lgkmcnt(4)
    v_mfma_f32_32x32x16_bf16 a[144:159], v[84:87], v[96:99], a[144:159]
    v_mfma_f32_32x32x16_bf16 a[128:143], v[84:87], v[100:103], a[128:143]
    ds_read_b64 v[76:77], v8 offset:256
    ds_read_b64 v[78:79], v8 offset:264
    ds_read_b128 v[88:91], v9 offset:7312
    ds_read_b128 v[92:95], v9 offset:4752
    s_waitcnt lgkmcnt(4)
    v_mfma_f32_32x32x16_bf16 a[144:159], v[72:75], v[104:107], a[144:159]
    v_mfma_f32_32x32x16_bf16 a[128:143], v[72:75], v[108:111], a[128:143]
    ds_read_b64 v[80:81], v8 offset:352
    ds_read_b64 v[82:83], v8 offset:360
    ds_read_b128 v[96:99], v9 offset:7200
    ds_read_b128 v[100:103], v9 offset:4640
    s_waitcnt lgkmcnt(4)
    v_mfma_f32_32x32x16_bf16 a[144:159], v[76:79], v[88:91], a[144:159]
    v_mfma_f32_32x32x16_bf16 a[128:143], v[76:79], v[92:95], a[128:143]
    ds_read_b64 v[84:85], v8 offset:320
    ds_read_b64 v[86:87], v8 offset:328
    ds_read_b128 v[104:107], v9 offset:7232
    ds_read_b128 v[108:111], v9 offset:4672
    s_waitcnt lgkmcnt(4)
    v_mfma_f32_32x32x16_bf16 a[144:159], v[80:83], v[96:99], a[144:159]
    v_mfma_f32_32x32x16_bf16 a[128:143], v[80:83], v[100:103], a[128:143]
    ds_read_b64 v[72:73], v8 offset:416
    ds_read_b64 v[74:75], v8 offset:424
    ds_read_b128 v[88:91], v9 offset:7120
    ds_read_b128 v[92:95], v9 offset:4560
    s_waitcnt lgkmcnt(4)
    v_mfma_f32_32x32x16_bf16 a[144:159], v[84:87], v[104:107], a[144:159]
    v_mfma_f32_32x32x16_bf16 a[128:143], v[84:87], v[108:111], a[128:143]
    ds_read_b64 v[76:77], v8 offset:384
    ds_read_b64 v[78:79], v8 offset:392
    ds_read_b128 v[96:99], v9 offset:7152
    ds_read_b128 v[100:103], v9 offset:4592
    s_waitcnt lgkmcnt(4)
    v_mfma_f32_32x32x16_bf16 a[144:159], v[72:75], v[88:91], a[144:159]
    v_mfma_f32_32x32x16_bf16 a[128:143], v[72:75], v[92:95], a[128:143]
    ds_read_b64 v[80:81], v8 offset:480
    ds_read_b64 v[82:83], v8 offset:488
    ds_read_b128 v[104:107], v9 offset:7040
    ds_read_b128 v[108:111], v9 offset:4480
    s_waitcnt lgkmcnt(4)
    v_mfma_f32_32x32x16_bf16 a[144:159], v[76:79], v[96:99], a[144:159]
    v_mfma_f32_32x32x16_bf16 a[128:143], v[76:79], v[100:103], a[128:143]
    ds_read_b64 v[84:85], v8 offset:448
    ds_read_b64 v[86:87], v8 offset:456
    ds_read_b128 v[88:91], v9 offset:7072
    ds_read_b128 v[92:95], v9 offset:4512
    s_waitcnt lgkmcnt(4)
    v_mfma_f32_32x32x16_bf16 a[144:159], v[80:83], v[104:107], a[144:159]
    v_mfma_f32_32x32x16_bf16 a[128:143], v[80:83], v[108:111], a[128:143]
    ds_read_b64 v[72:73], v8 offset:544
    ds_read_b64 v[74:75], v8 offset:552
    ds_read_b128 v[96:99], v9 offset:6960
    ds_read_b128 v[100:103], v9 offset:4400
    s_waitcnt lgkmcnt(4)
    v_mfma_f32_32x32x16_bf16 a[144:159], v[84:87], v[88:91], a[144:159]
    v_mfma_f32_32x32x16_bf16 a[128:143], v[84:87], v[92:95], a[128:143]
    ds_read_b64 v[76:77], v8 offset:512
    ds_read_b64 v[78:79], v8 offset:520
    ds_read_b128 v[104:107], v9 offset:6992
    ds_read_b128 v[108:111], v9 offset:4432
    s_waitcnt lgkmcnt(4)
    v_mfma_f32_32x32x16_bf16 a[144:159], v[72:75], v[96:99], a[144:159]
    v_mfma_f32_32x32x16_bf16 a[128:143], v[72:75], v[100:103], a[128:143]
    ds_read_b64 v[80:81], v8 offset:608
    ds_read_b64 v[82:83], v8 offset:616
    ds_read_b128 v[88:91], v9 offset:6880
    ds_read_b128 v[92:95], v9 offset:4320
    s_waitcnt lgkmcnt(4)
    v_mfma_f32_32x32x16_bf16 a[144:159], v[76:79], v[104:107], a[144:159]
    v_mfma_f32_32x32x16_bf16 a[128:143], v[76:79], v[108:111], a[128:143]
    ds_read_b64 v[84:85], v8 offset:576
    ds_read_b64 v[86:87], v8 offset:584
    ds_read_b128 v[96:99], v9 offset:6912
    ds_read_b128 v[100:103], v9 offset:4352
    s_waitcnt lgkmcnt(4)
    v_mfma_f32_32x32x16_bf16 a[144:159], v[80:83], v[88:91], a[144:159]
    v_mfma_f32_32x32x16_bf16 a[128:143], v[80:83], v[92:95], a[128:143]
    ds_read_b64 v[72:73], v8 offset:672
    ds_read_b64 v[74:75], v8 offset:680
    ds_read_b128 v[104:107], v9 offset:6800
    ds_read_b128 v[108:111], v9 offset:4240
    s_waitcnt lgkmcnt(4)
    v_mfma_f32_32x32x16_bf16 a[144:159], v[84:87], v[96:99], a[144:159]
    v_mfma_f32_32x32x16_bf16 a[128:143], v[84:87], v[100:103], a[128:143]
    ds_read_b64 v[76:77], v8 offset:640
    ds_read_b64 v[78:79], v8 offset:648
    ds_read_b128 v[88:91], v9 offset:6832
    ds_read_b128 v[92:95], v9 offset:4272
    s_waitcnt lgkmcnt(4)
    v_mfma_f32_32x32x16_bf16 a[144:159], v[72:75], v[104:107], a[144:159]
    v_mfma_f32_32x32x16_bf16 a[128:143], v[72:75], v[108:111], a[128:143]
    ds_read_b64 v[80:81], v8 offset:736
    ds_read_b64 v[82:83], v8 offset:744
    ds_read_b128 v[96:99], v9 offset:6720
    ds_read_b128 v[100:103], v9 offset:4160
    s_waitcnt lgkmcnt(4)
    v_mfma_f32_32x32x16_bf16 a[144:159], v[76:79], v[88:91], a[144:159]
    v_mfma_f32_32x32x16_bf16 a[128:143], v[76:79], v[92:95], a[128:143]
    ds_read_b64 v[84:85], v8 offset:704
    ds_read_b64 v[86:87], v8 offset:712
    ds_read_b128 v[104:107], v9 offset:6752
    ds_read_b128 v[108:111], v9 offset:4192
    s_waitcnt lgkmcnt(4)
    v_mfma_f32_32x32x16_bf16 a[144:159], v[80:83], v[96:99], a[144:159]
    v_mfma_f32_32x32x16_bf16 a[128:143], v[80:83], v[100:103], a[128:143]
    ds_read_b64 v[72:73], v8 offset:800
    ds_read_b64 v[74:75], v8 offset:808
    ds_read_b128 v[88:91], v9 offset:6640
    ds_read_b128 v[92:95], v9 offset:4080
    s_waitcnt lgkmcnt(4)
    v_mfma_f32_32x32x16_bf16 a[144:159], v[84:87], v[104:107], a[144:159]
    v_mfma_f32_32x32x16_bf16 a[128:143], v[84:87], v[108:111], a[128:143]
    ds_read_b64 v[76:77], v8 offset:768
    ds_read_b64 v[78:79], v8 offset:776
    ds_read_b128 v[96:99], v9 offset:6672
    ds_read_b128 v[100:103], v9 offset:4112
    s_waitcnt lgkmcnt(4)
    v_mfma_f32_32x32x16_bf16 a[144:159], v[72:75], v[88:91], a[144:159]
    v_mfma_f32_32x32x16_bf16 a[128:143], v[72:75], v[92:95], a[128:143]
    ds_read_b64 v[80:81], v8 offset:864
    ds_read_b64 v[82:83], v8 offset:872
    ds_read_b128 v[104:107], v9 offset:6560
    ds_read_b128 v[108:111], v9 offset:4000
    s_waitcnt lgkmcnt(4)
    v_mfma_f32_32x32x16_bf16 a[144:159], v[76:79], v[96:99], a[144:159]
    v_mfma_f32_32x32x16_bf16 a[128:143], v[76:79], v[100:103], a[128:143]
    ds_read_b64 v[84:85], v8 offset:832
    ds_read_b64 v[86:87], v8 offset:840
    ds_read_b128 v[88:91], v9 offset:6592
    ds_read_b128 v[92:95], v9 offset:4032
    s_waitcnt lgkmcnt(4)
    v_mfma_f32_32x32x16_bf16 a[144:159], v[80:83], v[104:107], a[144:159]
    v_mfma_f32_32x32x16_bf16 a[128:143], v[80:83], v[108:111], a[128:143]
    ds_read_b64 v[72:73], v8 offset:928
    ds_read_b64 v[74:75], v8 offset:936
    ds_read_b128 v[96:99], v9 offset:6480
    ds_read_b128 v[100:103], v9 offset:3920
    s_waitcnt lgkmcnt(4)
    v_mfma_f32_32x32x16_bf16 a[144:159], v[84:87], v[88:91], a[144:159]
    v_mfma_f32_32x32x16_bf16 a[128:143], v[84:87], v[92:95], a[128:143]
    ds_read_b64 v[76:77], v8 offset:896
    ds_read_b64 v[78:79], v8 offset:904
    ds_read_b128 v[104:107], v9 offset:6512
    ds_read_b128 v[108:111], v9 offset:3952
    s_waitcnt lgkmcnt(4)
    v_mfma_f32_32x32x16_bf16 a[144:159], v[72:75], v[96:99], a[144:159]
    v_mfma_f32_32x32x16_bf16 a[128:143], v[72:75], v[100:103], a[128:143]
    ds_read_b64 v[80:81], v8 offset:992
    ds_read_b64 v[82:83], v8 offset:1000
    ds_read_b128 v[88:91], v9 offset:6400
    ds_read_b128 v[92:95], v9 offset:3840
    s_waitcnt lgkmcnt(4)
    v_mfma_f32_32x32x16_bf16 a[144:159], v[76:79], v[104:107], a[144:159]
    v_mfma_f32_32x32x16_bf16 a[128:143], v[76:79], v[108:111], a[128:143]
    ds_read_b64 v[84:85], v8 offset:960
    ds_read_b64 v[86:87], v8 offset:968
    ds_read_b128 v[96:99], v9 offset:6432
    ds_read_b128 v[100:103], v9 offset:3872
    s_waitcnt lgkmcnt(4)
    v_mfma_f32_32x32x16_bf16 a[144:159], v[80:83], v[88:91], a[144:159]
    v_mfma_f32_32x32x16_bf16 a[128:143], v[80:83], v[92:95], a[128:143]
    ds_read_b64 v[72:73], v8 offset:1056
    ds_read_b64 v[74:75], v8 offset:1064
    ds_read_b128 v[104:107], v9 offset:6320
    ds_read_b128 v[108:111], v9 offset:3760
    s_waitcnt lgkmcnt(4)
    v_mfma_f32_32x32x16_bf16 a[144:159], v[84:87], v[96:99], a[144:159]
    v_mfma_f32_32x32x16_bf16 a[128:143], v[84:87], v[100:103], a[128:143]
    ds_read_b64 v[76:77], v8 offset:1024
    ds_read_b64 v[78:79], v8 offset:1032
    ds_read_b128 v[88:91], v9 offset:6352
    ds_read_b128 v[92:95], v9 offset:3792
    s_waitcnt lgkmcnt(4)
    v_mfma_f32_32x32x16_bf16 a[144:159], v[72:75], v[104:107], a[144:159]
    v_mfma_f32_32x32x16_bf16 a[128:143], v[72:75], v[108:111], a[128:143]
    ds_read_b64 v[80:81], v8 offset:1120
    ds_read_b64 v[82:83], v8 offset:1128
    ds_read_b128 v[96:99], v9 offset:6240
    ds_read_b128 v[100:103], v9 offset:3680
    s_waitcnt lgkmcnt(4)
    v_mfma_f32_32x32x16_bf16 a[144:159], v[76:79], v[88:91], a[144:159]
    v_mfma_f32_32x32x16_bf16 a[128:143], v[76:79], v[92:95], a[128:143]
    ds_read_b64 v[84:85], v8 offset:1088
    ds_read_b64 v[86:87], v8 offset:1096
    ds_read_b128 v[104:107], v9 offset:6272
    ds_read_b128 v[108:111], v9 offset:3712
    s_waitcnt lgkmcnt(4)
    v_mfma_f32_32x32x16_bf16 a[144:159], v[80:83], v[96:99], a[144:159]
    v_mfma_f32_32x32x16_bf16 a[128:143], v[80:83], v[100:103], a[128:143]
    ds_read_b64 v[72:73], v8 offset:1184
    ds_read_b64 v[74:75], v8 offset:1192
    ds_read_b128 v[88:91], v9 offset:6160
    ds_read_b128 v[92:95], v9 offset:3600
    s_waitcnt lgkmcnt(4)
    v_mfma_f32_32x32x16_bf16 a[144:159], v[84:87], v[104:107], a[144:159]
    v_mfma_f32_32x32x16_bf16 a[128:143], v[84:87], v[108:111], a[128:143]
    ds_read_b64 v[76:77], v8 offset:1152
    ds_read_b64 v[78:79], v8 offset:1160
    ds_read_b128 v[96:99], v9 offset:6192
    ds_read_b128 v[100:103], v9 offset:3632
    s_waitcnt lgkmcnt(4)
    v_mfma_f32_32x32x16_bf16 a[144:159], v[72:75], v[88:91], a[144:159]
    v_mfma_f32_32x32x16_bf16 a[128:143], v[72:75], v[92:95], a[128:143]
    ds_read_b64 v[80:81], v8 offset:1248
    ds_read_b64 v[82:83], v8 offset:1256
    ds_read_b128 v[104:107], v9 offset:6080
    ds_read_b128 v[108:111], v9 offset:3520
    s_waitcnt lgkmcnt(4)
    v_mfma_f32_32x32x16_bf16 a[144:159], v[76:79], v[96:99], a[144:159]
    v_mfma_f32_32x32x16_bf16 a[128:143], v[76:79], v[100:103], a[128:143]
    ds_read_b64 v[84:85], v8 offset:1216
    ds_read_b64 v[86:87], v8 offset:1224
    ds_read_b128 v[88:91], v9 offset:6112
    ds_read_b128 v[92:95], v9 offset:3552
    s_waitcnt lgkmcnt(4)
    v_mfma_f32_32x32x16_bf16 a[144:159], v[80:83], v[104:107], a[144:159]
    v_mfma_f32_32x32x16_bf16 a[128:143], v[80:83], v[108:111], a[128:143]
    ds_read_b64 v[72:73], v8 offset:1312
    ds_read_b64 v[74:75], v8 offset:1320
    ds_read_b128 v[96:99], v9 offset:6000
    ds_read_b128 v[100:103], v9 offset:3440
    s_waitcnt lgkmcnt(4)
    v_mfma_f32_32x32x16_bf16 a[144:159], v[84:87], v[88:91], a[144:159]
    v_mfma_f32_32x32x16_bf16 a[128:143], v[84:87], v[92:95], a[128:143]
    ds_read_b64 v[76:77], v8 offset:1280
    ds_read_b64 v[78:79], v8 offset:1288
    ds_read_b128 v[104:107], v9 offset:6032
    ds_read_b128 v[108:111], v9 offset:3472
    s_waitcnt lgkmcnt(4)
    v_mfma_f32_32x32x16_bf16 a[144:159], v[72:75], v[96:99], a[144:159]
    v_mfma_f32_32x32x16_bf16 a[128:143], v[72:75], v[100:103], a[128:143]
    ds_read_b64 v[80:81], v8 offset:1376
    ds_read_b64 v[82:83], v8 offset:1384
    ds_read_b128 v[88:91], v9 offset:5920
    ds_read_b128 v[92:95], v9 offset:3360
    s_waitcnt lgkmcnt(4)
    v_mfma_f32_32x32x16_bf16 a[144:159], v[76:79], v[104:107], a[144:159]
    v_mfma_f32_32x32x16_bf16 a[128:143], v[76:79], v[108:111], a[128:143]
    ds_read_b64 v[84:85], v8 offset:1344
    ds_read_b64 v[86:87], v8 offset:1352
    ds_read_b128 v[96:99], v9 offset:5952
    ds_read_b128 v[100:103], v9 offset:3392
    s_waitcnt lgkmcnt(4)
    v_mfma_f32_32x32x16_bf16 a[144:159], v[80:83], v[88:91], a[144:159]
    v_mfma_f32_32x32x16_bf16 a[128:143], v[80:83], v[92:95], a[128:143]
    ds_read_b64 v[72:73], v8 offset:1440
    ds_read_b64 v[74:75], v8 offset:1448
    ds_read_b128 v[104:107], v9 offset:5840
    ds_read_b128 v[108:111], v9 offset:3280
    s_waitcnt lgkmcnt(4)
    v_mfma_f32_32x32x16_bf16 a[144:159], v[84:87], v[96:99], a[144:159]
    v_mfma_f32_32x32x16_bf16 a[128:143], v[84:87], v[100:103], a[128:143]
    ds_read_b64 v[76:77], v8 offset:1408
    ds_read_b64 v[78:79], v8 offset:1416
    ds_read_b128 v[88:91], v9 offset:5872
    ds_read_b128 v[92:95], v9 offset:3312
    s_waitcnt lgkmcnt(4)
    v_mfma_f32_32x32x16_bf16 a[144:159], v[72:75], v[104:107], a[144:159]
    v_mfma_f32_32x32x16_bf16 a[128:143], v[72:75], v[108:111], a[128:143]
    ds_read_b64 v[80:81], v8 offset:1504
    ds_read_b64 v[82:83], v8 offset:1512
    ds_read_b128 v[96:99], v9 offset:5760
    ds_read_b128 v[100:103], v9 offset:3200
    s_waitcnt lgkmcnt(4)
    v_mfma_f32_32x32x16_bf16 a[144:159], v[76:79], v[88:91], a[144:159]
    v_mfma_f32_32x32x16_bf16 a[128:143], v[76:79], v[92:95], a[128:143]
    ds_read_b64 v[84:85], v8 offset:1472
    ds_read_b64 v[86:87], v8 offset:1480
    ds_read_b128 v[104:107], v9 offset:5792
    ds_read_b128 v[108:111], v9 offset:3232
    s_waitcnt lgkmcnt(4)
    v_mfma_f32_32x32x16_bf16 a[144:159], v[80:83], v[96:99], a[144:159]
    v_mfma_f32_32x32x16_bf16 a[128:143], v[80:83], v[100:103], a[128:143]
    ds_read_b64 v[72:73], v8 offset:1568
    ds_read_b64 v[74:75], v8 offset:1576
    ds_read_b128 v[88:91], v9 offset:5680
    ds_read_b128 v[92:95], v9 offset:3120
    s_waitcnt lgkmcnt(4)
    v_mfma_f32_32x32x16_bf16 a[144:159], v[84:87], v[104:107], a[144:159]
    v_mfma_f32_32x32x16_bf16 a[128:143], v[84:87], v[108:111], a[128:143]
    ds_read_b64 v[76:77], v8 offset:1536
    ds_read_b64 v[78:79], v8 offset:1544
    ds_read_b128 v[96:99], v9 offset:5712
    ds_read_b128 v[100:103], v9 offset:3152
    s_waitcnt lgkmcnt(4)
    v_mfma_f32_32x32x16_bf16 a[144:159], v[72:75], v[88:91], a[144:159]
    v_mfma_f32_32x32x16_bf16 a[128:143], v[72:75], v[92:95], a[128:143]
    ds_read_b64 v[80:81], v8 offset:1632
    ds_read_b64 v[82:83], v8 offset:1640
    ds_read_b128 v[104:107], v9 offset:5600
    ds_read_b128 v[108:111], v9 offset:3040
    s_waitcnt lgkmcnt(4)
    v_mfma_f32_32x32x16_bf16 a[144:159], v[76:79], v[96:99], a[144:159]
    v_mfma_f32_32x32x16_bf16 a[128:143], v[76:79], v[100:103], a[128:143]
    ds_read_b64 v[84:85], v8 offset:1600
    ds_read_b64 v[86:87], v8 offset:1608
    ds_read_b128 v[88:91], v9 offset:5632
    ds_read_b128 v[92:95], v9 offset:3072
    s_waitcnt lgkmcnt(4)
    v_mfma_f32_32x32x16_bf16 a[144:159], v[80:83], v[104:107], a[144:159]
    v_mfma_f32_32x32x16_bf16 a[128:143], v[80:83], v[108:111], a[128:143]
    ds_read_b64 v[72:73], v8 offset:1696
    ds_read_b64 v[74:75], v8 offset:1704
    ds_read_b128 v[96:99], v9 offset:5520
    ds_read_b128 v[100:103], v9 offset:2960
    s_waitcnt lgkmcnt(4)
    v_mfma_f32_32x32x16_bf16 a[144:159], v[84:87], v[88:91], a[144:159]
    v_mfma_f32_32x32x16_bf16 a[128:143], v[84:87], v[92:95], a[128:143]
    ds_read_b64 v[76:77], v8 offset:1664
    ds_read_b64 v[78:79], v8 offset:1672
    ds_read_b128 v[104:107], v9 offset:5552
    ds_read_b128 v[108:111], v9 offset:2992
    s_waitcnt lgkmcnt(4)
    v_mfma_f32_32x32x16_bf16 a[144:159], v[72:75], v[96:99], a[144:159]
    v_mfma_f32_32x32x16_bf16 a[128:143], v[72:75], v[100:103], a[128:143]
    ds_read_b64 v[80:81], v8 offset:1760
    ds_read_b64 v[82:83], v8 offset:1768
    ds_read_b128 v[88:91], v9 offset:5440
    ds_read_b128 v[92:95], v9 offset:2880
    s_waitcnt lgkmcnt(4)
    v_mfma_f32_32x32x16_bf16 a[144:159], v[76:79], v[104:107], a[144:159]
    v_mfma_f32_32x32x16_bf16 a[128:143], v[76:79], v[108:111], a[128:143]
    ds_read_b64 v[84:85], v8 offset:1728
    ds_read_b64 v[86:87], v8 offset:1736
    ds_read_b128 v[96:99], v9 offset:5472
    ds_read_b128 v[100:103], v9 offset:2912
    s_waitcnt lgkmcnt(4)
    v_mfma_f32_32x32x16_bf16 a[144:159], v[80:83], v[88:91], a[144:159]
    v_mfma_f32_32x32x16_bf16 a[128:143], v[80:83], v[92:95], a[128:143]
    ds_read_b64 v[72:73], v8 offset:1824
    ds_read_b64 v[74:75], v8 offset:1832
    ds_read_b128 v[104:107], v9 offset:5360
    ds_read_b128 v[108:111], v9 offset:2800
    s_waitcnt lgkmcnt(4)
    v_mfma_f32_32x32x16_bf16 a[144:159], v[84:87], v[96:99], a[144:159]
    v_mfma_f32_32x32x16_bf16 a[128:143], v[84:87], v[100:103], a[128:143]
    ds_read_b64 v[76:77], v8 offset:1792
    ds_read_b64 v[78:79], v8 offset:1800
    ds_read_b128 v[88:91], v9 offset:5392
    ds_read_b128 v[92:95], v9 offset:2832
    s_waitcnt lgkmcnt(4)
    v_mfma_f32_32x32x16_bf16 a[144:159], v[72:75], v[104:107], a[144:159]
    v_mfma_f32_32x32x16_bf16 a[128:143], v[72:75], v[108:111], a[128:143]
    ds_read_b64 v[80:81], v8 offset:1888
    ds_read_b64 v[82:83], v8 offset:1896
    ds_read_b128 v[96:99], v9 offset:5280
    ds_read_b128 v[100:103], v9 offset:2720
    s_waitcnt lgkmcnt(4)
    v_mfma_f32_32x32x16_bf16 a[144:159], v[76:79], v[88:91], a[144:159]
    v_mfma_f32_32x32x16_bf16 a[128:143], v[76:79], v[92:95], a[128:143]
    ds_read_b64 v[84:85], v8 offset:1856
    ds_read_b64 v[86:87], v8 offset:1864
    ds_read_b128 v[104:107], v9 offset:5312
    ds_read_b128 v[108:111], v9 offset:2752
    s_waitcnt lgkmcnt(4)
    v_mfma_f32_32x32x16_bf16 a[144:159], v[80:83], v[96:99], a[144:159]
    v_mfma_f32_32x32x16_bf16 a[128:143], v[80:83], v[100:103], a[128:143]
    ds_read_b64 v[72:73], v8 offset:1952
    ds_read_b64 v[74:75], v8 offset:1960
    ds_read_b128 v[88:91], v9 offset:5200
    ds_read_b128 v[92:95], v9 offset:2640
    s_waitcnt lgkmcnt(4)
    v_mfma_f32_32x32x16_bf16 a[144:159], v[84:87], v[104:107], a[144:159]
    v_mfma_f32_32x32x16_bf16 a[128:143], v[84:87], v[108:111], a[128:143]
    ds_read_b64 v[76:77], v8 offset:1920
    ds_read_b64 v[78:79], v8 offset:1928
    ds_read_b128 v[96:99], v9 offset:5232
    ds_read_b128 v[100:103], v9 offset:2672
    s_waitcnt lgkmcnt(4)
    v_mfma_f32_32x32x16_bf16 a[144:159], v[72:75], v[88:91], a[144:159]
    v_mfma_f32_32x32x16_bf16 a[128:143], v[72:75], v[92:95], a[128:143]
    ds_read_b64 v[80:81], v8 offset:2016
    ds_read_b64 v[82:83], v8 offset:2024
    ds_read_b128 v[104:107], v9 offset:5120
    ds_read_b128 v[108:111], v9 offset:2560
    s_waitcnt lgkmcnt(4)
    v_mfma_f32_32x32x16_bf16 a[144:159], v[76:79], v[96:99], a[144:159]
    v_mfma_f32_32x32x16_bf16 a[128:143], v[76:79], v[100:103], a[128:143]
    ds_read_b64 v[84:85], v8 offset:1984
    ds_read_b64 v[86:87], v8 offset:1992
    ds_read_b128 v[88:91], v9 offset:5152
    ds_read_b128 v[92:95], v9 offset:2592
    s_waitcnt lgkmcnt(4)
    v_mfma_f32_32x32x16_bf16 a[144:159], v[80:83], v[104:107], a[144:159]
    v_mfma_f32_32x32x16_bf16 a[128:143], v[80:83], v[108:111], a[128:143]
    ds_read_b64 v[72:73], v8 offset:2080
    ds_read_b64 v[74:75], v8 offset:2088
    ds_read_b128 v[96:99], v9 offset:5040
    s_waitcnt lgkmcnt(3)
    v_mfma_f32_32x32x16_bf16 a[144:159], v[84:87], v[88:91], a[144:159]
    v_mfma_f32_32x32x16_bf16 a[128:143], v[84:87], v[92:95], a[128:143]
    ds_read_b64 v[76:77], v8 offset:2048
    ds_read_b64 v[78:79], v8 offset:2056
    ds_read_b128 v[104:107], v9 offset:5072
    s_waitcnt lgkmcnt(3)
    v_mfma_f32_32x32x16_bf16 a[144:159], v[72:75], v[96:99], a[144:159]
    ds_read_b64 v[80:81], v8 offset:2144
    ds_read_b64 v[82:83], v8 offset:2152
    ds_read_b128 v[88:91], v9 offset:4960
    s_waitcnt lgkmcnt(3)
    v_mfma_f32_32x32x16_bf16 a[144:159], v[76:79], v[104:107], a[144:159]
    ds_read_b64 v[84:85], v8 offset:2112
    ds_read_b64 v[86:87], v8 offset:2120
    ds_read_b128 v[96:99], v9 offset:4992
    s_waitcnt lgkmcnt(3)
    v_mfma_f32_32x32x16_bf16 a[144:159], v[80:83], v[88:91], a[144:159]
    ds_read_b64 v[72:73], v8 offset:2208
    ds_read_b64 v[74:75], v8 offset:2216
    ds_read_b128 v[104:107], v9 offset:4880
    s_waitcnt lgkmcnt(3)
    v_mfma_f32_32x32x16_bf16 a[144:159], v[84:87], v[96:99], a[144:159]
    ds_read_b64 v[76:77], v8 offset:2176
    ds_read_b64 v[78:79], v8 offset:2184
    ds_read_b128 v[88:91], v9 offset:4912
    s_waitcnt lgkmcnt(3)
    v_mfma_f32_32x32x16_bf16 a[144:159], v[72:75], v[104:107], a[144:159]
    ds_read_b64 v[80:81], v8 offset:2272
    ds_read_b64 v[82:83], v8 offset:2280
    ds_read_b128 v[96:99], v9 offset:4800
    s_waitcnt lgkmcnt(3)
    v_mfma_f32_32x32x16_bf16 a[144:159], v[76:79], v[88:91], a[144:159]
    ds_read_b64 v[84:85], v8 offset:2240
    ds_read_b64 v[86:87], v8 offset:2248
    ds_read_b128 v[104:107], v9 offset:4832
    s_waitcnt lgkmcnt(3)
    v_mfma_f32_32x32x16_bf16 a[144:159], v[80:83], v[96:99], a[144:159]
    ds_read_b64 v[72:73], v8 offset:2336
    ds_read_b64 v[74:75], v8 offset:2344
    ds_read_b128 v[88:91], v9 offset:4720
    s_waitcnt lgkmcnt(3)
    v_mfma_f32_32x32x16_bf16 a[144:159], v[84:87], v[104:107], a[144:159]
    ds_read_b64 v[76:77], v8 offset:2304
    ds_read_b64 v[78:79], v8 offset:2312
    ds_read_b128 v[96:99], v9 offset:4752
    s_waitcnt lgkmcnt(3)
    v_mfma_f32_32x32x16_bf16 a[144:159], v[72:75], v[88:91], a[144:159]
    ds_read_b64 v[80:81], v8 offset:2400
    ds_read_b64 v[82:83], v8 offset:2408
    ds_read_b128 v[104:107], v9 offset:4640
    s_waitcnt lgkmcnt(3)
    v_mfma_f32_32x32x16_bf16 a[144:159], v[76:79], v[96:99], a[144:159]
    ds_read_b64 v[84:85], v8 offset:2368
    ds_read_b64 v[86:87], v8 offset:2376
    ds_read_b128 v[88:91], v9 offset:4672
    s_waitcnt lgkmcnt(3)
    v_mfma_f32_32x32x16_bf16 a[144:159], v[80:83], v[104:107], a[144:159]
    ds_read_b64 v[72:73], v8 offset:2464
    ds_read_b64 v[74:75], v8 offset:2472
    ds_read_b128 v[96:99], v9 offset:4560
    s_waitcnt lgkmcnt(3)
    v_mfma_f32_32x32x16_bf16 a[144:159], v[84:87], v[88:91], a[144:159]
    ds_read_b64 v[76:77], v8 offset:2432
    ds_read_b64 v[78:79], v8 offset:2440
    ds_read_b128 v[104:107], v9 offset:4592
    s_waitcnt lgkmcnt(3)
    v_mfma_f32_32x32x16_bf16 a[144:159], v[72:75], v[96:99], a[144:159]
    ds_read_b64 v[80:81], v8 offset:2528
    ds_read_b64 v[82:83], v8 offset:2536
    ds_read_b128 v[88:91], v9 offset:4480
    s_waitcnt lgkmcnt(3)
    v_mfma_f32_32x32x16_bf16 a[144:159], v[76:79], v[104:107], a[144:159]
    ds_read_b64 v[84:85], v8 offset:2496
    ds_read_b64 v[86:87], v8 offset:2504
    ds_read_b128 v[96:99], v9 offset:4512
    s_waitcnt lgkmcnt(3)
    v_mfma_f32_32x32x16_bf16 a[144:159], v[80:83], v[88:91], a[144:159]
    ds_read_b64 v[72:73], v8 offset:2592
    ds_read_b64 v[74:75], v8 offset:2600
    ds_read_b128 v[104:107], v9 offset:4400
    s_waitcnt lgkmcnt(3)
    v_mfma_f32_32x32x16_bf16 a[144:159], v[84:87], v[96:99], a[144:159]
    ds_read_b64 v[76:77], v8 offset:2560
    ds_read_b64 v[78:79], v8 offset:2568
    ds_read_b128 v[88:91], v9 offset:4432
    s_waitcnt lgkmcnt(3)
    v_mfma_f32_32x32x16_bf16 a[144:159], v[72:75], v[104:107], a[144:159]
    ds_read_b64 v[80:81], v8 offset:2656
    ds_read_b64 v[82:83], v8 offset:2664
    ds_read_b128 v[96:99], v9 offset:4320
    s_waitcnt lgkmcnt(3)
    v_mfma_f32_32x32x16_bf16 a[144:159], v[76:79], v[88:91], a[144:159]
    ds_read_b64 v[84:85], v8 offset:2624
    ds_read_b64 v[86:87], v8 offset:2632
    ds_read_b128 v[104:107], v9 offset:4352
    s_waitcnt lgkmcnt(3)
    v_mfma_f32_32x32x16_bf16 a[144:159], v[80:83], v[96:99], a[144:159]
    ds_read_b64 v[72:73], v8 offset:2720
    ds_read_b64 v[74:75], v8 offset:2728
    ds_read_b128 v[88:91], v9 offset:4240
    s_waitcnt lgkmcnt(3)
    v_mfma_f32_32x32x16_bf16 a[144:159], v[84:87], v[104:107], a[144:159]
    ds_read_b64 v[76:77], v8 offset:2688
    ds_read_b64 v[78:79], v8 offset:2696
    ds_read_b128 v[96:99], v9 offset:4272
    s_waitcnt lgkmcnt(3)
    v_mfma_f32_32x32x16_bf16 a[144:159], v[72:75], v[88:91], a[144:159]
    ds_read_b64 v[80:81], v8 offset:2784
    ds_read_b64 v[82:83], v8 offset:2792
    ds_read_b128 v[104:107], v9 offset:4160
    s_waitcnt lgkmcnt(3)
    v_mfma_f32_32x32x16_bf16 a[144:159], v[76:79], v[96:99], a[144:159]
    ds_read_b64 v[84:85], v8 offset:2752
    ds_read_b64 v[86:87], v8 offset:2760
    ds_read_b128 v[88:91], v9 offset:4192
    s_waitcnt lgkmcnt(3)
    v_mfma_f32_32x32x16_bf16 a[144:159], v[80:83], v[104:107], a[144:159]
    ds_read_b64 v[72:73], v8 offset:2848
    ds_read_b64 v[74:75], v8 offset:2856
    ds_read_b128 v[96:99], v9 offset:4080
    s_waitcnt lgkmcnt(3)
    v_mfma_f32_32x32x16_bf16 a[144:159], v[84:87], v[88:91], a[144:159]
    ds_read_b64 v[76:77], v8 offset:2816
    ds_read_b64 v[78:79], v8 offset:2824
    ds_read_b128 v[104:107], v9 offset:4112
    s_waitcnt lgkmcnt(3)
    v_mfma_f32_32x32x16_bf16 a[144:159], v[72:75], v[96:99], a[144:159]
    ds_read_b64 v[80:81], v8 offset:2912
    ds_read_b64 v[82:83], v8 offset:2920
    ds_read_b128 v[88:91], v9 offset:4000
    s_waitcnt lgkmcnt(3)
    v_mfma_f32_32x32x16_bf16 a[144:159], v[76:79], v[104:107], a[144:159]
    ds_read_b64 v[84:85], v8 offset:2880
    ds_read_b64 v[86:87], v8 offset:2888
    ds_read_b128 v[96:99], v9 offset:4032
    s_waitcnt lgkmcnt(3)
    v_mfma_f32_32x32x16_bf16 a[144:159], v[80:83], v[88:91], a[144:159]
    ds_read_b64 v[72:73], v8 offset:2976
    ds_read_b64 v[74:75], v8 offset:2984
    ds_read_b128 v[104:107], v9 offset:3920
    s_waitcnt lgkmcnt(3)
    v_mfma_f32_32x32x16_bf16 a[144:159], v[84:87], v[96:99], a[144:159]
    ds_read_b64 v[76:77], v8 offset:2944
    ds_read_b64 v[78:79], v8 offset:2952
    ds_read_b128 v[88:91], v9 offset:3952
    s_waitcnt lgkmcnt(3)
    v_mfma_f32_32x32x16_bf16 a[144:159], v[72:75], v[104:107], a[144:159]
    ds_read_b64 v[80:81], v8 offset:3040
    ds_read_b64 v[82:83], v8 offset:3048
    ds_read_b128 v[96:99], v9 offset:3840
    s_waitcnt lgkmcnt(3)
    v_mfma_f32_32x32x16_bf16 a[144:159], v[76:79], v[88:91], a[144:159]
    ds_read_b64 v[84:85], v8 offset:3008
    ds_read_b64 v[86:87], v8 offset:3016
    ds_read_b128 v[104:107], v9 offset:3872
    s_waitcnt lgkmcnt(3)
    v_mfma_f32_32x32x16_bf16 a[144:159], v[80:83], v[96:99], a[144:159]
    ds_read_b64 v[72:73], v8 offset:3104
    ds_read_b64 v[74:75], v8 offset:3112
    ds_read_b128 v[88:91], v9 offset:3760
    s_waitcnt lgkmcnt(3)
    v_mfma_f32_32x32x16_bf16 a[144:159], v[84:87], v[104:107], a[144:159]
    ds_read_b64 v[76:77], v8 offset:3072
    ds_read_b64 v[78:79], v8 offset:3080
    ds_read_b128 v[96:99], v9 offset:3792
    s_waitcnt lgkmcnt(3)
    v_mfma_f32_32x32x16_bf16 a[144:159], v[72:75], v[88:91], a[144:159]
    ds_read_b64 v[80:81], v8 offset:3168
    ds_read_b64 v[82:83], v8 offset:3176
    ds_read_b128 v[104:107], v9 offset:3680
    s_waitcnt lgkmcnt(3)
    v_mfma_f32_32x32x16_bf16 a[144:159], v[76:79], v[96:99], a[144:159]
    ds_read_b64 v[84:85], v8 offset:3136
    ds_read_b64 v[86:87], v8 offset:3144
    ds_read_b128 v[88:91], v9 offset:3712
    s_waitcnt lgkmcnt(3)
    v_mfma_f32_32x32x16_bf16 a[144:159], v[80:83], v[104:107], a[144:159]
    ds_read_b64 v[72:73], v8 offset:3232
    ds_read_b64 v[74:75], v8 offset:3240
    ds_read_b128 v[96:99], v9 offset:3600
    s_waitcnt lgkmcnt(3)
    v_mfma_f32_32x32x16_bf16 a[144:159], v[84:87], v[88:91], a[144:159]
    ds_read_b64 v[76:77], v8 offset:3200
    ds_read_b64 v[78:79], v8 offset:3208
    ds_read_b128 v[104:107], v9 offset:3632
    s_waitcnt lgkmcnt(3)
    v_mfma_f32_32x32x16_bf16 a[144:159], v[72:75], v[96:99], a[144:159]
    ds_read_b64 v[80:81], v8 offset:3296
    ds_read_b64 v[82:83], v8 offset:3304
    ds_read_b128 v[88:91], v9 offset:3520
    s_waitcnt lgkmcnt(3)
    v_mfma_f32_32x32x16_bf16 a[144:159], v[76:79], v[104:107], a[144:159]
    ds_read_b64 v[84:85], v8 offset:3264
    ds_read_b64 v[86:87], v8 offset:3272
    ds_read_b128 v[96:99], v9 offset:3552
    s_waitcnt lgkmcnt(3)
    v_mfma_f32_32x32x16_bf16 a[144:159], v[80:83], v[88:91], a[144:159]
    ds_read_b64 v[72:73], v8 offset:3360
    ds_read_b64 v[74:75], v8 offset:3368
    ds_read_b128 v[104:107], v9 offset:3440
    s_waitcnt lgkmcnt(3)
    v_mfma_f32_32x32x16_bf16 a[144:159], v[84:87], v[96:99], a[144:159]
    ds_read_b64 v[76:77], v8 offset:3328
    ds_read_b64 v[78:79], v8 offset:3336
    ds_read_b128 v[88:91], v9 offset:3472
    s_waitcnt lgkmcnt(3)
    v_mfma_f32_32x32x16_bf16 a[144:159], v[72:75], v[104:107], a[144:159]
    ds_read_b64 v[80:81], v8 offset:3424
    ds_read_b64 v[82:83], v8 offset:3432
    ds_read_b128 v[96:99], v9 offset:3360
    s_waitcnt lgkmcnt(3)
    v_mfma_f32_32x32x16_bf16 a[144:159], v[76:79], v[88:91], a[144:159]
    ds_read_b64 v[84:85], v8 offset:3392
    ds_read_b64 v[86:87], v8 offset:3400
    ds_read_b128 v[104:107], v9 offset:3392
    s_waitcnt lgkmcnt(3)
    v_mfma_f32_32x32x16_bf16 a[144:159], v[80:83], v[96:99], a[144:159]
    ds_read_b64 v[72:73], v8 offset:3488
    ds_read_b64 v[74:75], v8 offset:3496
    ds_read_b128 v[88:91], v9 offset:3280
    s_waitcnt lgkmcnt(3)
    v_mfma_f32_32x32x16_bf16 a[144:159], v[84:87], v[104:107], a[144:159]
    ds_read_b64 v[76:77], v8 offset:3456
    ds_read_b64 v[78:79], v8 offset:3464
    ds_read_b128 v[96:99], v9 offset:3312
    s_waitcnt lgkmcnt(3)
    v_mfma_f32_32x32x16_bf16 a[144:159], v[72:75], v[88:91], a[144:159]
    ds_read_b64 v[80:81], v8 offset:3552
    ds_read_b64 v[82:83], v8 offset:3560
    ds_read_b128 v[104:107], v9 offset:3200
    s_waitcnt lgkmcnt(3)
    v_mfma_f32_32x32x16_bf16 a[144:159], v[76:79], v[96:99], a[144:159]
    ds_read_b64 v[84:85], v8 offset:3520
    ds_read_b64 v[86:87], v8 offset:3528
    ds_read_b128 v[88:91], v9 offset:3232
    s_waitcnt lgkmcnt(3)
    v_mfma_f32_32x32x16_bf16 a[144:159], v[80:83], v[104:107], a[144:159]
    ds_read_b64 v[72:73], v8 offset:3616
    ds_read_b64 v[74:75], v8 offset:3624
    ds_read_b128 v[96:99], v9 offset:3120
    s_waitcnt lgkmcnt(3)
    v_mfma_f32_32x32x16_bf16 a[144:159], v[84:87], v[88:91], a[144:159]
    ds_read_b64 v[76:77], v8 offset:3584
    ds_read_b64 v[78:79], v8 offset:3592
    ds_read_b128 v[104:107], v9 offset:3152
    s_waitcnt lgkmcnt(3)
    v_mfma_f32_32x32x16_bf16 a[144:159], v[72:75], v[96:99], a[144:159]
    ds_read_b64 v[80:81], v8 offset:3680
    ds_read_b64 v[82:83], v8 offset:3688
    ds_read_b128 v[88:91], v9 offset:3040
    s_waitcnt lgkmcnt(3)
    v_mfma_f32_32x32x16_bf16 a[144:159], v[76:79], v[104:107], a[144:159]
    ds_read_b64 v[84:85], v8 offset:3648
    ds_read_b64 v[86:87], v8 offset:3656
    ds_read_b128 v[96:99], v9 offset:3072
    s_waitcnt lgkmcnt(3)
    v_mfma_f32_32x32x16_bf16 a[144:159], v[80:83], v[88:91], a[144:159]
    ds_read_b64 v[72:73], v8 offset:3744
    ds_read_b64 v[74:75], v8 offset:3752
    ds_read_b128 v[104:107], v9 offset:2960
    s_waitcnt lgkmcnt(3)
    v_mfma_f32_32x32x16_bf16 a[144:159], v[84:87], v[96:99], a[144:159]
    ds_read_b64 v[76:77], v8 offset:3712
    ds_read_b64 v[78:79], v8 offset:3720
    ds_read_b128 v[88:91], v9 offset:2992
    s_waitcnt lgkmcnt(3)
    v_mfma_f32_32x32x16_bf16 a[144:159], v[72:75], v[104:107], a[144:159]
    ds_read_b64 v[80:81], v8 offset:3808
    ds_read_b64 v[82:83], v8 offset:3816
    ds_read_b128 v[96:99], v9 offset:2880
    s_waitcnt lgkmcnt(3)
    v_mfma_f32_32x32x16_bf16 a[144:159], v[76:79], v[88:91], a[144:159]
    ds_read_b64 v[84:85], v8 offset:3776
    ds_read_b64 v[86:87], v8 offset:3784
    ds_read_b128 v[104:107], v9 offset:2912
    s_waitcnt lgkmcnt(3)
    v_mfma_f32_32x32x16_bf16 a[144:159], v[80:83], v[96:99], a[144:159]
    ds_read_b64 v[72:73], v8 offset:3872
    ds_read_b64 v[74:75], v8 offset:3880
    ds_read_b128 v[88:91], v9 offset:2800
    s_waitcnt lgkmcnt(3)
    v_mfma_f32_32x32x16_bf16 a[144:159], v[84:87], v[104:107], a[144:159]
    ds_read_b64 v[76:77], v8 offset:3840
    ds_read_b64 v[78:79], v8 offset:3848
    ds_read_b128 v[96:99], v9 offset:2832
    s_waitcnt lgkmcnt(3)
    v_mfma_f32_32x32x16_bf16 a[144:159], v[72:75], v[88:91], a[144:159]
    ds_read_b64 v[80:81], v8 offset:3936
    ds_read_b64 v[82:83], v8 offset:3944
    ds_read_b128 v[104:107], v9 offset:2720
    s_waitcnt lgkmcnt(3)
    v_mfma_f32_32x32x16_bf16 a[144:159], v[76:79], v[96:99], a[144:159]
    ds_read_b64 v[84:85], v8 offset:3904
    ds_read_b64 v[86:87], v8 offset:3912
    ds_read_b128 v[88:91], v9 offset:2752
    s_waitcnt lgkmcnt(3)
    v_mfma_f32_32x32x16_bf16 a[144:159], v[80:83], v[104:107], a[144:159]
    ds_read_b64 v[72:73], v8 offset:4000
    ds_read_b64 v[74:75], v8 offset:4008
    ds_read_b128 v[96:99], v9 offset:2640
    s_waitcnt lgkmcnt(3)
    v_mfma_f32_32x32x16_bf16 a[144:159], v[84:87], v[88:91], a[144:159]
    ds_read_b64 v[76:77], v8 offset:3968
    ds_read_b64 v[78:79], v8 offset:3976
    ds_read_b128 v[104:107], v9 offset:2672
    s_waitcnt lgkmcnt(3)
    v_mfma_f32_32x32x16_bf16 a[144:159], v[72:75], v[96:99], a[144:159]
    ds_read_b64 v[80:81], v8 offset:4064
    ds_read_b64 v[82:83], v8 offset:4072
    ds_read_b128 v[88:91], v9 offset:2560
    s_waitcnt lgkmcnt(3)
    v_mfma_f32_32x32x16_bf16 a[144:159], v[76:79], v[104:107], a[144:159]
    ds_read_b64 v[84:85], v8 offset:4032
    ds_read_b64 v[86:87], v8 offset:4040
    ds_read_b128 v[96:99], v9 offset:2592
    s_waitcnt lgkmcnt(3)
    v_mfma_f32_32x32x16_bf16 a[144:159], v[80:83], v[88:91], a[144:159]
    s_waitcnt lgkmcnt(0)
    v_mfma_f32_32x32x16_bf16 a[144:159], v[84:87], v[96:99], a[144:159]
    s_nop 15
    v_lshlrev_b32 v10, 6, v6
    v_lshlrev_b32 v11, 3, v7
    v_add_u32 v10, v10, v11
    s_lshl_b32 s28, s21, 12
    s_add_u32 s28, s28, 101376
    v_add_u32 v10, s28, v10
    v_accvgpr_read_b32 v72, a128
    v_accvgpr_read_b32 v73, a129
    v_accvgpr_read_b32 v74, a130
    v_accvgpr_read_b32 v75, a131
    s_nop 0
    v_cvt_pk_bf16_f32 v76, v72, v73
    v_cvt_pk_bf16_f32 v77, v74, v75
    ds_write_b64 v10, v[76:77] offset:0
    s_nop 1
    v_accvgpr_read_b32 v72, a132
    v_accvgpr_read_b32 v73, a133
    v_accvgpr_read_b32 v74, a134
    v_accvgpr_read_b32 v75, a135
    s_nop 0
    v_cvt_pk_bf16_f32 v76, v72, v73
    v_cvt_pk_bf16_f32 v77, v74, v75
    ds_write_b64 v10, v[76:77] offset:16
    s_nop 1
    v_accvgpr_read_b32 v72, a136
    v_accvgpr_read_b32 v73, a137
    v_accvgpr_read_b32 v74, a138
    v_accvgpr_read_b32 v75, a139
    s_nop 0
    v_cvt_pk_bf16_f32 v76, v72, v73
    v_cvt_pk_bf16_f32 v77, v74, v75
    ds_write_b64 v10, v[76:77] offset:32
    s_nop 1
    v_accvgpr_read_b32 v72, a140
    v_accvgpr_read_b32 v73, a141
    v_accvgpr_read_b32 v74, a142
    v_accvgpr_read_b32 v75, a143
    s_nop 0
    v_cvt_pk_bf16_f32 v76, v72, v73
    v_cvt_pk_bf16_f32 v77, v74, v75
    ds_write_b64 v10, v[76:77] offset:48
    s_nop 1
    v_accvgpr_read_b32 v72, a144
    v_accvgpr_read_b32 v73, a145
    v_accvgpr_read_b32 v74, a146
    v_accvgpr_read_b32 v75, a147
    s_nop 0
    v_cvt_pk_bf16_f32 v76, v72, v73
    v_cvt_pk_bf16_f32 v77, v74, v75
    ds_write_b64 v10, v[76:77] offset:2048
    s_nop 1
    v_accvgpr_read_b32 v72, a148
    v_accvgpr_read_b32 v73, a149
    v_accvgpr_read_b32 v74, a150
    v_accvgpr_read_b32 v75, a151
    s_nop 0
    v_cvt_pk_bf16_f32 v76, v72, v73
    v_cvt_pk_bf16_f32 v77, v74, v75
    ds_write_b64 v10, v[76:77] offset:2064
    s_nop 1
    v_accvgpr_read_b32 v72, a152
    v_accvgpr_read_b32 v73, a153
    v_accvgpr_read_b32 v74, a154
    v_accvgpr_read_b32 v75, a155
    s_nop 0
    v_cvt_pk_bf16_f32 v76, v72, v73
    v_cvt_pk_bf16_f32 v77, v74, v75
    ds_write_b64 v10, v[76:77] offset:2080
    s_nop 1
    v_accvgpr_read_b32 v72, a156
    v_accvgpr_read_b32 v73, a157
    v_accvgpr_read_b32 v74, a158
    v_accvgpr_read_b32 v75, a159
    s_nop 0
    v_cvt_pk_bf16_f32 v76, v72, v73
    v_cvt_pk_bf16_f32 v77, v74, v75
    ds_write_b64 v10, v[76:77] offset:2096
    s_nop 1
    s_waitcnt lgkmcnt(0)
    s_barrier
    v_lshlrev_b32 v4, 4, v3
    v_add_u32 v4, 101376, v4
    ds_read_b128 v[72:75], v4 offset:0
    ds_read_b128 v[76:79], v4 offset:4096
    ds_read_b128 v[80:83], v4 offset:8192
    ds_read_b128 v[84:87], v4 offset:12288
    s_waitcnt lgkmcnt(0) vmcnt(0)
    s_mov_b32 s8, s76
    s_mov_b32 s9, s77
    s_mov_b32 s10, 0x400000
    s_mov_b32 s11, 0x20000
    v_lshlrev_b32 v92, 16, v72
    v_and_b32 v94, 0xffff0000, v59
    v_fmac_f32 v92, v94, v112
    v_lshlrev_b32 v94, 16, v16
    v_mul_f32 v92, v92, v94
    v_lshlrev_b32 v93, 16, v76
    v_and_b32 v94, 0xffff0000, v63
    v_fmac_f32 v93, v94, v113
    v_and_b32 v94, 0xffff0000, v16
    v_mul_f32 v93, v93, v94
    v_cvt_pk_bf16_f32 v40, v92, v93
    v_lshlrev_b32 v92, 16, v80
    v_and_b32 v94, 0xffff0000, v67
    v_fmac_f32 v92, v94, v114
    v_lshlrev_b32 v94, 16, v17
    v_mul_f32 v92, v92, v94
    v_lshlrev_b32 v93, 16, v84
    v_and_b32 v94, 0xffff0000, v71
    v_fmac_f32 v93, v94, v115
    v_and_b32 v94, 0xffff0000, v17
    v_mul_f32 v93, v93, v94
    v_cvt_pk_bf16_f32 v41, v92, v93
    v_and_b32 v92, 0xffff0000, v72
    v_lshlrev_b32 v94, 16, v59
    v_fmac_f32 v92, v94, v112
    v_lshlrev_b32 v94, 16, v18
    v_mul_f32 v92, v92, v94
    v_and_b32 v93, 0xffff0000, v76
    v_lshlrev_b32 v94, 16, v63
    v_fmac_f32 v93, v94, v113
    v_and_b32 v94, 0xffff0000, v18
    v_mul_f32 v93, v93, v94
    v_cvt_pk_bf16_f32 v42, v92, v93
    v_and_b32 v92, 0xffff0000, v80
    v_lshlrev_b32 v94, 16, v67
    v_fmac_f32 v92, v94, v114
    v_lshlrev_b32 v94, 16, v19
    v_mul_f32 v92, v92, v94
    v_and_b32 v93, 0xffff0000, v84
    v_lshlrev_b32 v94, 16, v71
    v_fmac_f32 v93, v94, v115
    v_and_b32 v94, 0xffff0000, v19
    v_mul_f32 v93, v93, v94
    v_cvt_pk_bf16_f32 v43, v92, v93
    v_lshlrev_b32 v92, 16, v73
    v_and_b32 v94, 0xffff0000, v58
    v_fmac_f32 v92, v94, v112
    v_lshlrev_b32 v94, 16, v20
    v_mul_f32 v92, v92, v94
    v_lshlrev_b32 v93, 16, v77
    v_and_b32 v94, 0xffff0000, v62
    v_fmac_f32 v93, v94, v113
    v_and_b32 v94, 0xffff0000, v20
    v_mul_f32 v93, v93, v94
    v_cvt_pk_bf16_f32 v44, v92, v93
    v_lshlrev_b32 v92, 16, v81
    v_and_b32 v94, 0xffff0000, v66
    v_fmac_f32 v92, v94, v114
    v_lshlrev_b32 v94, 16, v21
    v_mul_f32 v92, v92, v94
    v_lshlrev_b32 v93, 16, v85
    v_and_b32 v94, 0xffff0000, v70
    v_fmac_f32 v93, v94, v115
    v_and_b32 v94, 0xffff0000, v21
    v_mul_f32 v93, v93, v94
    v_cvt_pk_bf16_f32 v45, v92, v93
    v_and_b32 v92, 0xffff0000, v73
    v_lshlrev_b32 v94, 16, v58
    v_fmac_f32 v92, v94, v112
    v_lshlrev_b32 v94, 16, v22
    v_mul_f32 v92, v92, v94
    v_and_b32 v93, 0xffff0000, v77
    v_lshlrev_b32 v94, 16, v62
    v_fmac_f32 v93, v94, v113
    v_and_b32 v94, 0xffff0000, v22
    v_mul_f32 v93, v93, v94
    v_cvt_pk_bf16_f32 v46, v92, v93
    v_and_b32 v92, 0xffff0000, v81
    v_lshlrev_b32 v94, 16, v66
    v_fmac_f32 v92, v94, v114
    v_lshlrev_b32 v94, 16, v23
    v_mul_f32 v92, v92, v94
    v_and_b32 v93, 0xffff0000, v85
    v_lshlrev_b32 v94, 16, v70
    v_fmac_f32 v93, v94, v115
    v_and_b32 v94, 0xffff0000, v23
    v_mul_f32 v93, v93, v94
    v_cvt_pk_bf16_f32 v47, v92, v93
    v_lshlrev_b32 v92, 16, v74
    v_and_b32 v94, 0xffff0000, v57
    v_fmac_f32 v92, v94, v112
    v_lshlrev_b32 v94, 16, v24
    v_mul_f32 v92, v92, v94
    v_lshlrev_b32 v93, 16, v78
    v_and_b32 v94, 0xffff0000, v61
    v_fmac_f32 v93, v94, v113
    v_and_b32 v94, 0xffff0000, v24
    v_mul_f32 v93, v93, v94
    v_cvt_pk_bf16_f32 v48, v92, v93
    v_lshlrev_b32 v92, 16, v82
    v_and_b32 v94, 0xffff0000, v65
    v_fmac_f32 v92, v94, v114
    v_lshlrev_b32 v94, 16, v25
    v_mul_f32 v92, v92, v94
    v_lshlrev_b32 v93, 16, v86
    v_and_b32 v94, 0xffff0000, v69
    v_fmac_f32 v93, v94, v115
    v_and_b32 v94, 0xffff0000, v25
    v_mul_f32 v93, v93, v94
    v_cvt_pk_bf16_f32 v49, v92, v93
    v_and_b32 v92, 0xffff0000, v74
    v_lshlrev_b32 v94, 16, v57
    v_fmac_f32 v92, v94, v112
    v_lshlrev_b32 v94, 16, v26
    v_mul_f32 v92, v92, v94
    v_and_b32 v93, 0xffff0000, v78
    v_lshlrev_b32 v94, 16, v61
    v_fmac_f32 v93, v94, v113
    v_and_b32 v94, 0xffff0000, v26
    v_mul_f32 v93, v93, v94
    v_cvt_pk_bf16_f32 v50, v92, v93
    v_and_b32 v92, 0xffff0000, v82
    v_lshlrev_b32 v94, 16, v65
    v_fmac_f32 v92, v94, v114
    v_lshlrev_b32 v94, 16, v27
    v_mul_f32 v92, v92, v94
    v_and_b32 v93, 0xffff0000, v86
    v_lshlrev_b32 v94, 16, v69
    v_fmac_f32 v93, v94, v115
    v_and_b32 v94, 0xffff0000, v27
    v_mul_f32 v93, v93, v94
    v_cvt_pk_bf16_f32 v51, v92, v93
    v_lshlrev_b32 v92, 16, v75
    v_and_b32 v94, 0xffff0000, v56
    v_fmac_f32 v92, v94, v112
    v_lshlrev_b32 v94, 16, v28
    v_mul_f32 v92, v92, v94
    v_lshlrev_b32 v93, 16, v79
    v_and_b32 v94, 0xffff0000, v60
    v_fmac_f32 v93, v94, v113
    v_and_b32 v94, 0xffff0000, v28
    v_mul_f32 v93, v93, v94
    v_cvt_pk_bf16_f32 v52, v92, v93
    v_lshlrev_b32 v92, 16, v83
    v_and_b32 v94, 0xffff0000, v64
    v_fmac_f32 v92, v94, v114
    v_lshlrev_b32 v94, 16, v29
    v_mul_f32 v92, v92, v94
    v_lshlrev_b32 v93, 16, v87
    v_and_b32 v94, 0xffff0000, v68
    v_fmac_f32 v93, v94, v115
    v_and_b32 v94, 0xffff0000, v29
    v_mul_f32 v93, v93, v94
    v_cvt_pk_bf16_f32 v53, v92, v93
    v_and_b32 v92, 0xffff0000, v75
    v_lshlrev_b32 v94, 16, v56
    v_fmac_f32 v92, v94, v112
    v_lshlrev_b32 v94, 16, v30
    v_mul_f32 v92, v92, v94
    v_and_b32 v93, 0xffff0000, v79
    v_lshlrev_b32 v94, 16, v60
    v_fmac_f32 v93, v94, v113
    v_and_b32 v94, 0xffff0000, v30
    v_mul_f32 v93, v93, v94
    v_cvt_pk_bf16_f32 v54, v92, v93
    v_and_b32 v92, 0xffff0000, v83
    v_lshlrev_b32 v94, 16, v64
    v_fmac_f32 v92, v94, v114
    v_lshlrev_b32 v94, 16, v31
    v_mul_f32 v92, v92, v94
    v_and_b32 v93, 0xffff0000, v87
    v_lshlrev_b32 v94, 16, v68
    v_fmac_f32 v93, v94, v115
    v_and_b32 v94, 0xffff0000, v31
    v_mul_f32 v93, v93, v94
    v_cvt_pk_bf16_f32 v55, v92, v93
    v_lshlrev_b32 v4, 14, v3
    s_lshl_b32 s28, s44, 3
    v_add_u32 v4, s28, v4
    v_add_u32 v5, 0, v4
    buffer_store_dwordx2 v[40:41], v5, s[8:11], 0 offen
    v_add_u32 v5, 2048, v4
    buffer_store_dwordx2 v[42:43], v5, s[8:11], 0 offen
    v_add_u32 v5, 4096, v4
    buffer_store_dwordx2 v[44:45], v5, s[8:11], 0 offen
    v_add_u32 v5, 6144, v4
    buffer_store_dwordx2 v[46:47], v5, s[8:11], 0 offen
    v_add_u32 v5, 8192, v4
    buffer_store_dwordx2 v[48:49], v5, s[8:11], 0 offen
    v_add_u32 v5, 10240, v4
    buffer_store_dwordx2 v[50:51], v5, s[8:11], 0 offen
    v_add_u32 v5, 12288, v4
    buffer_store_dwordx2 v[52:53], v5, s[8:11], 0 offen
    v_add_u32 v5, 14336, v4
    buffer_store_dwordx2 v[54:55], v5, s[8:11], 0 offen
    s_waitcnt vmcnt(0)
    s_barrier
    s_load_dwordx2 s[30:31], s[0:1], 48
    s_waitcnt lgkmcnt(0)
    s_mov_b32 s12, s30
    s_mov_b32 s13, s31
    s_mov_b32 s14, 0x200000
    s_mov_b32 s15, 0x20000
L_cv_skip_24:
    v_lshrrev_b32 v30, 4, v0
    s_load_dwordx2 s[30:31], s[0:1], 104
    s_and_b32 s44, s21, 1
    s_lshr_b32 s45, s21, 1
    v_lshrrev_b32 v1, 2, v30
    v_lshrrev_b32 v2, 4, v30
    v_xor_b32 v2, v2, v30
    v_and_b32 v2, 3, v2
    v_lshlrev_b32 v2, 4, v2
    v_lshlrev_b32 v1, 10, v1
    v_add_u32 v1, v1, v2
    v_and_b32 v5, 15, v30
    v_lshrrev_b32 v2, 2, v5
    v_lshrrev_b32 v34, 4, v30
    v_xor_b32 v2, v2, v34
    v_and_b32 v2, 3, v2
    v_lshlrev_b32 v5, 2, v5
    v_add_u32 v5, v5, v2
    v_lshlrev_b32 v5, 4, v5
    v_and_b32 v3, 15, v30
    v_lshrrev_b32 v2, 4, v30
    v_lshlrev_b32 v2, 2, v2
    v_sub_u32 v3, v3, v2
    s_lshl_b32 s28, s44, 4
    v_add_u32 v3, s28, v3
    v_bfe_u32 v4, v30, 2, 2
    v_lshlrev_b32 v4, 13, v4
    v_lshrrev_b32 v2, 4, v30
    v_lshlrev_b32 v2, 6, v2
    v_add_u32 v4, v4, v2
    v_and_b32 v2, 3, v30
    v_lshlrev_b32 v2, 4, v2
    v_add_u32 v4, v4, v2
    v_add_u32 v4, s98, v4
    v_and_b32 v6, 1, v30
    v_lshlrev_b32 v6, 4, v6
    v_mov_b32 v7, 0x3f80
    v_lshlrev_b32 v7, v6, v7
    v_bfe_u32 v6, v30, 1, 2
    v_cmp_eq_u32 vcc, 0, v6
    s_nop 1
    v_cndmask_b32 v12, 0, v7, vcc
    v_cmp_eq_u32 vcc, 1, v6
    s_nop 1
    v_cndmask_b32 v13, 0, v7, vcc
    v_cmp_eq_u32 vcc, 2, v6
    s_nop 1
    v_cndmask_b32 v14, 0, v7, vcc
    v_cmp_eq_u32 vcc, 3, v6
    s_nop 1
    v_cndmask_b32 v15, 0, v7, vcc
    v_add_u32 v6, 86016, v0
    ds_write_b128 v6, v[12:15]
    s_waitcnt lgkmcnt(0)
    s_mov_b32 s16, s30
    s_mov_b32 s17, s31
    s_mov_b32 s18, 0x400000
    s_mov_b32 s19, 0x20000
    s_mov_b32 s52, 0x3e0293ee
    s_lshl_b32 s46, s23, 21
    s_add_u32 s46, s46, 67108864
    s_sub_u32 s40, s23, 1
    s_mov_b32 s41, 0
    s_mov_b32 s43, 0
    s_mov_b32 s47, 0
    s_lshr_b32 s28, s21, 1
    s_lshl_b32 s29, s40, 15
    s_lshl_b32 s30, s28, 14
    s_add_u32 s29, s29, s30
    s_and_b32 s30, s21, 1
    s_lshl_b32 s31, s30, 9
    s_add_u32 s29, s29, s31
    s_lshl_b32 s31, s21, 13
    s_add_u32 s31, s31, s43
    s_add_u32 m0, s31, 0
    s_add_u32 s30, s29, 0
    buffer_load_dwordx4 v1, s[12:15], s30 offen lds
    s_add_u32 m0, s31, 1024
    s_add_u32 s30, s29, 64
    buffer_load_dwordx4 v1, s[12:15], s30 offen lds
    s_add_u32 m0, s31, 2048
    s_add_u32 s30, s29, 128
    buffer_load_dwordx4 v1, s[12:15], s30 offen lds
    s_add_u32 m0, s31, 3072
    s_add_u32 s30, s29, 192
    buffer_load_dwordx4 v1, s[12:15], s30 offen lds
    s_add_u32 m0, s31, 4096
    s_add_u32 s30, s29, 256
    buffer_load_dwordx4 v1, s[12:15], s30 offen lds
    s_add_u32 m0, s31, 5120
    s_add_u32 s30, s29, 320
    buffer_load_dwordx4 v1, s[12:15], s30 offen lds
    s_add_u32 m0, s31, 6144
    s_add_u32 s30, s29, 384
    buffer_load_dwordx4 v1, s[12:15], s30 offen lds
    s_add_u32 m0, s31, 7168
    s_add_u32 s30, s29, 448
    buffer_load_dwordx4 v1, s[12:15], s30 offen lds
    s_and_b32 s33, s23, 3
    s_lshl_b32 s33, s33, 6
    s_lshr_b32 s29, s23, 2
    s_lshl_b32 s29, s29, 2
    s_add_u32 s33, s33, s29
    s_add_u32 s33, s33, 16
    s_cmp_lg_u32 s21, 0
    s_cbranch_scc1 L_x2_init_x
    s_mov_b64 exec, 1
    v_mov_b32 v32, s33
    s_mov_b32 s29, 0
L_x2_init:
    global_load_dword v33, v32, s[24:25] sc0 sc1
    s_waitcnt vmcnt(0)
    v_readfirstlane_b32 s30, v33
    s_add_u32 s29, s29, 1
    s_cmp_gt_u32 s29, 0x40000
    s_cbranch_scc1 L_x2_init_d
    s_cmp_ge_u32 s30, 32
    s_cbranch_scc1 L_x2_init_d
    s_sleep 8
    s_branch L_x2_init
L_x2_init_d:
    s_mov_b64 exec, s[26:27]
L_x2_init_x:
L_x2:
    s_cmp_lg_u32 s21, 0
    s_cbranch_scc1 L_x2kv_25_s
    s_mov_b64 exec, 1
    v_mov_b32 v6, 0
    s_lshl_b32 s28, s23, 12
    s_lshl_b32 s29, s22, 7
    s_add_u32 s28, s28, s29
    s_add_u32 s28, s28, 47005696
    s_mov_b32 s29, 0
L_x2kv_25:
    buffer_load_dword v7, v6, s[4:7], s28 offen sc0 sc1
    s_waitcnt vmcnt(0)
    v_readfirstlane_b32 s30, v7
    s_add_u32 s29, s29, 1
    s_cmp_gt_u32 s29, 0x80000
    s_cbranch_scc1 L_x2kv_25_d
    s_cmp_gt_u32 s30, s41
    s_cbranch_scc1 L_x2kv_25_d
    s_sleep 8
    s_branch L_x2kv_25
L_x2kv_25_d:
    s_mov_b64 exec, s[26:27]
L_x2kv_25_s:
    s_waitcnt vmcnt(0)
    s_barrier
    s_lshl_b32 s28, s40, 18
    s_add_u32 s28, s28, s97
    s_add_u32 s29, s28, 0
    s_add_u32 s30, s29, 4096
    buffer_load_dwordx4 v[12:15], v0, s[4:7], s29 offen offset:0 sc1
    buffer_load_dwordx4 v[16:19], v0, s[4:7], s29 offen offset:1024 sc1
    buffer_load_dwordx4 v[20:23], v0, s[4:7], s29 offen offset:2048 sc1
    buffer_load_dwordx4 v[24:27], v0, s[4:7], s29 offen offset:3072 sc1
    buffer_load_dwordx4 v[28:31], v0, s[4:7], s30 offen offset:0 sc1
    buffer_load_dwordx4 v[32:35], v0, s[4:7], s30 offen offset:1024 sc1
    buffer_load_dwordx4 v[36:39], v0, s[4:7], s30 offen offset:2048 sc1
    buffer_load_dwordx4 v[40:43], v0, s[4:7], s30 offen offset:3072 sc1
    s_lshl_b32 s29, s45, 12
    s_add_u32 s29, s29, s28
    s_add_u32 s29, s29, 16777216
    buffer_load_dwordx4 v[44:47], v0, s[4:7], s29 offen offset:0 sc1
    buffer_load_dwordx4 v[48:51], v0, s[4:7], s29 offen offset:1024 sc1
    buffer_load_dwordx4 v[52:55], v0, s[4:7], s29 offen offset:2048 sc1
    buffer_load_dwordx4 v[56:59], v0, s[4:7], s29 offen offset:3072 sc1
    s_add_u32 s32, s41, 1
    s_cmp_ge_u32 s32, s42
    s_cbranch_scc1 L_x2n_26
    s_add_u32 s33, s40, 7
    s_xor_b32 s36, s43, 32768
    s_lshr_b32 s28, s21, 1
    s_lshl_b32 s29, s33, 15
    s_lshl_b32 s30, s28, 14
    s_add_u32 s29, s29, s30
    s_and_b32 s30, s21, 1
    s_lshl_b32 s31, s30, 9
    s_add_u32 s29, s29, s31
    s_lshl_b32 s31, s21, 13
    s_add_u32 s31, s31, s36
    s_add_u32 m0, s31, 0
    s_add_u32 s30, s29, 0
    buffer_load_dwordx4 v1, s[12:15], s30 offen lds
    s_add_u32 m0, s31, 1024
    s_add_u32 s30, s29, 64
    buffer_load_dwordx4 v1, s[12:15], s30 offen lds
    s_add_u32 m0, s31, 2048
    s_add_u32 s30, s29, 128
    buffer_load_dwordx4 v1, s[12:15], s30 offen lds
    s_add_u32 m0, s31, 3072
    s_add_u32 s30, s29, 192
    buffer_load_dwordx4 v1, s[12:15], s30 offen lds
    s_add_u32 m0, s31, 4096
    s_add_u32 s30, s29, 256
    buffer_load_dwordx4 v1, s[12:15], s30 offen lds
    s_add_u32 m0, s31, 5120
    s_add_u32 s30, s29, 320
    buffer_load_dwordx4 v1, s[12:15], s30 offen lds
    s_add_u32 m0, s31, 6144
    s_add_u32 s30, s29, 384
    buffer_load_dwordx4 v1, s[12:15], s30 offen lds
    s_add_u32 m0, s31, 7168
    s_add_u32 s30, s29, 448
    buffer_load_dwordx4 v1, s[12:15], s30 offen lds
L_x2n_26:
    v_add_u32 v2, s43, v5
    ds_read_b128 v[88:91], v2 offset:0
    ds_read_b128 v[92:95], v2 offset:16384
    ds_read_b128 v[96:99], v2 offset:1024
    ds_read_b128 v[100:103], v2 offset:17408
    s_waitcnt lgkmcnt(2)
    v_mfma_f32_16x16x32_bf16 v[60:63], a[0:3], v[88:91], 0
    v_mfma_f32_16x16x32_bf16 v[64:67], a[0:3], v[92:95], 0
    v_mfma_f32_16x16x32_bf16 v[68:71], a[64:67], v[88:91], 0
    v_mfma_f32_16x16x32_bf16 v[72:75], a[64:67], v[92:95], 0
    ds_read_b128 v[88:91], v2 offset:2048
    ds_read_b128 v[92:95], v2 offset:18432
    s_waitcnt lgkmcnt(2)
    v_mfma_f32_16x16x32_bf16 v[60:63], a[4:7], v[96:99], v[60:63]
    v_mfma_f32_16x16x32_bf16 v[64:67], a[4:7], v[100:103], v[64:67]
    v_mfma_f32_16x16x32_bf16 v[68:71], a[68:71], v[96:99], v[68:71]
    v_mfma_f32_16x16x32_bf16 v[72:75], a[68:71], v[100:103], v[72:75]
    ds_read_b128 v[96:99], v2 offset:3072
    ds_read_b128 v[100:103], v2 offset:19456
    s_waitcnt lgkmcnt(2)
    v_mfma_f32_16x16x32_bf16 v[60:63], a[8:11], v[88:91], v[60:63]
    v_mfma_f32_16x16x32_bf16 v[64:67], a[8:11], v[92:95], v[64:67]
    v_mfma_f32_16x16x32_bf16 v[68:71], a[72:75], v[88:91], v[68:71]
    v_mfma_f32_16x16x32_bf16 v[72:75], a[72:75], v[92:95], v[72:75]
    ds_read_b128 v[88:91], v2 offset:4096
    ds_read_b128 v[92:95], v2 offset:20480
    s_waitcnt lgkmcnt(2)
    v_mfma_f32_16x16x32_bf16 v[60:63], a[12:15], v[96:99], v[60:63]
    v_mfma_f32_16x16x32_bf16 v[64:67], a[12:15], v[100:103], v[64:67]
    v_mfma_f32_16x16x32_bf16 v[68:71], a[76:79], v[96:99], v[68:71]
    v_mfma_f32_16x16x32_bf16 v[72:75], a[76:79], v[100:103], v[72:75]
    ds_read_b128 v[96:99], v2 offset:5120
    ds_read_b128 v[100:103], v2 offset:21504
    s_waitcnt lgkmcnt(2)
    v_mfma_f32_16x16x32_bf16 v[60:63], a[16:19], v[88:91], v[60:63]
    v_mfma_f32_16x16x32_bf16 v[64:67], a[16:19], v[92:95], v[64:67]
    v_mfma_f32_16x16x32_bf16 v[68:71], a[80:83], v[88:91], v[68:71]
    v_mfma_f32_16x16x32_bf16 v[72:75], a[80:83], v[92:95], v[72:75]
    ds_read_b128 v[88:91], v2 offset:6144
    ds_read_b128 v[92:95], v2 offset:22528
    s_waitcnt lgkmcnt(2)
    v_mfma_f32_16x16x32_bf16 v[60:63], a[20:23], v[96:99], v[60:63]
    v_mfma_f32_16x16x32_bf16 v[64:67], a[20:23], v[100:103], v[64:67]
    v_mfma_f32_16x16x32_bf16 v[68:71], a[84:87], v[96:99], v[68:71]
    v_mfma_f32_16x16x32_bf16 v[72:75], a[84:87], v[100:103], v[72:75]
    ds_read_b128 v[96:99], v2 offset:7168
    ds_read_b128 v[100:103], v2 offset:23552
    s_waitcnt lgkmcnt(2)
    v_mfma_f32_16x16x32_bf16 v[60:63], a[24:27], v[88:91], v[60:63]
    v_mfma_f32_16x16x32_bf16 v[64:67], a[24:27], v[92:95], v[64:67]
    v_mfma_f32_16x16x32_bf16 v[68:71], a[88:91], v[88:91], v[68:71]
    v_mfma_f32_16x16x32_bf16 v[72:75], a[88:91], v[92:95], v[72:75]
    ds_read_b128 v[88:91], v2 offset:8192
    ds_read_b128 v[92:95], v2 offset:24576
    s_waitcnt lgkmcnt(2)
    v_mfma_f32_16x16x32_bf16 v[60:63], a[28:31], v[96:99], v[60:63]
    v_mfma_f32_16x16x32_bf16 v[64:67], a[28:31], v[100:103], v[64:67]
    v_mfma_f32_16x16x32_bf16 v[68:71], a[92:95], v[96:99], v[68:71]
    v_mfma_f32_16x16x32_bf16 v[72:75], a[92:95], v[100:103], v[72:75]
    ds_read_b128 v[96:99], v2 offset:9216
    ds_read_b128 v[100:103], v2 offset:25600
    s_waitcnt lgkmcnt(2)
    v_mfma_f32_16x16x32_bf16 v[60:63], a[32:35], v[88:91], v[60:63]
    v_mfma_f32_16x16x32_bf16 v[64:67], a[32:35], v[92:95], v[64:67]
    v_mfma_f32_16x16x32_bf16 v[68:71], a[96:99], v[88:91], v[68:71]
    v_mfma_f32_16x16x32_bf16 v[72:75], a[96:99], v[92:95], v[72:75]
    ds_read_b128 v[88:91], v2 offset:10240
    ds_read_b128 v[92:95], v2 offset:26624
    s_waitcnt lgkmcnt(2)
    v_mfma_f32_16x16x32_bf16 v[60:63], a[36:39], v[96:99], v[60:63]
    v_mfma_f32_16x16x32_bf16 v[64:67], a[36:39], v[100:103], v[64:67]
    v_mfma_f32_16x16x32_bf16 v[68:71], a[100:103], v[96:99], v[68:71]
    v_mfma_f32_16x16x32_bf16 v[72:75], a[100:103], v[100:103], v[72:75]
    ds_read_b128 v[96:99], v2 offset:11264
    ds_read_b128 v[100:103], v2 offset:27648
    s_waitcnt lgkmcnt(2)
    v_mfma_f32_16x16x32_bf16 v[60:63], a[40:43], v[88:91], v[60:63]
    v_mfma_f32_16x16x32_bf16 v[64:67], a[40:43], v[92:95], v[64:67]
    v_mfma_f32_16x16x32_bf16 v[68:71], a[104:107], v[88:91], v[68:71]
    v_mfma_f32_16x16x32_bf16 v[72:75], a[104:107], v[92:95], v[72:75]
    ds_read_b128 v[88:91], v2 offset:12288
    ds_read_b128 v[92:95], v2 offset:28672
    s_waitcnt lgkmcnt(2)
    v_mfma_f32_16x16x32_bf16 v[60:63], a[44:47], v[96:99], v[60:63]
    v_mfma_f32_16x16x32_bf16 v[64:67], a[44:47], v[100:103], v[64:67]
    v_mfma_f32_16x16x32_bf16 v[68:71], a[108:111], v[96:99], v[68:71]
    v_mfma_f32_16x16x32_bf16 v[72:75], a[108:111], v[100:103], v[72:75]
    ds_read_b128 v[96:99], v2 offset:13312
    ds_read_b128 v[100:103], v2 offset:29696
    s_waitcnt lgkmcnt(2)
    v_mfma_f32_16x16x32_bf16 v[60:63], a[48:51], v[88:91], v[60:63]
    v_mfma_f32_16x16x32_bf16 v[64:67], a[48:51], v[92:95], v[64:67]
    v_mfma_f32_16x16x32_bf16 v[68:71], a[112:115], v[88:91], v[68:71]
    v_mfma_f32_16x16x32_bf16 v[72:75], a[112:115], v[92:95], v[72:75]
    ds_read_b128 v[88:91], v2 offset:14336
    ds_read_b128 v[92:95], v2 offset:30720
    s_waitcnt lgkmcnt(2)
    v_mfma_f32_16x16x32_bf16 v[60:63], a[52:55], v[96:99], v[60:63]
    v_mfma_f32_16x16x32_bf16 v[64:67], a[52:55], v[100:103], v[64:67]
    v_mfma_f32_16x16x32_bf16 v[68:71], a[116:119], v[96:99], v[68:71]
    v_mfma_f32_16x16x32_bf16 v[72:75], a[116:119], v[100:103], v[72:75]
    ds_read_b128 v[96:99], v2 offset:15360
    ds_read_b128 v[100:103], v2 offset:31744
    s_waitcnt lgkmcnt(2)
    v_mfma_f32_16x16x32_bf16 v[60:63], a[56:59], v[88:91], v[60:63]
    v_mfma_f32_16x16x32_bf16 v[64:67], a[56:59], v[92:95], v[64:67]
    v_mfma_f32_16x16x32_bf16 v[68:71], a[120:123], v[88:91], v[68:71]
    v_mfma_f32_16x16x32_bf16 v[72:75], a[120:123], v[92:95], v[72:75]
    s_waitcnt lgkmcnt(0)
    v_mfma_f32_16x16x32_bf16 v[60:63], a[60:63], v[96:99], v[60:63]
    v_mfma_f32_16x16x32_bf16 v[64:67], a[60:63], v[100:103], v[64:67]
    v_mfma_f32_16x16x32_bf16 v[68:71], a[124:127], v[96:99], v[68:71]
    v_mfma_f32_16x16x32_bf16 v[72:75], a[124:127], v[100:103], v[72:75]
    s_nop 7
    v_cvt_pk_bf16_f32 v112, v60, v61
    v_cvt_pk_bf16_f32 v113, v62, v63
    v_cvt_pk_bf16_f32 v114, v68, v69
    v_cvt_pk_bf16_f32 v115, v70, v71
    v_cvt_pk_bf16_f32 v116, v64, v65
    v_cvt_pk_bf16_f32 v117, v66, v67
    v_cvt_pk_bf16_f32 v118, v72, v73
    v_cvt_pk_bf16_f32 v119, v74, v75
    s_lshl_b32 s28, s21, 10
    s_add_u32 s28, s28, 65536
    v_add_u32 v2, s28, v0
    ds_write_b128 v2, v[112:115] offset:0
    ds_write_b128 v2, v[116:119] offset:4096
    s_waitcnt lgkmcnt(0)
    s_barrier
    s_lshl_b32 s28, s44, 12
    s_add_u32 s28, s28, 65536
    v_add_u32 v2, s28, v0
    ds_read_b128 v[60:63], v2 offset:0
    ds_read_b128 v[64:67], v2 offset:1024
    ds_read_b128 v[68:71], v2 offset:2048
    ds_read_b128 v[72:75], v2 offset:3072
    s_waitcnt vmcnt(12)
    s_cmp_lt_u32 s32, s42
    s_cbranch_scc1 L_x2w_27
    s_waitcnt vmcnt(4)
L_x2w_27:
    s_waitcnt lgkmcnt(3)
    v_mfma_f32_16x16x32_bf16 v[76:79], v[12:15], v[60:63], 0
    v_mfma_f32_16x16x32_bf16 v[80:83], v[28:31], v[60:63], 0
    s_waitcnt lgkmcnt(2)
    v_mfma_f32_16x16x32_bf16 v[76:79], v[16:19], v[64:67], v[76:79]
    v_mfma_f32_16x16x32_bf16 v[80:83], v[32:35], v[64:67], v[80:83]
    s_waitcnt lgkmcnt(1)
    v_mfma_f32_16x16x32_bf16 v[76:79], v[20:23], v[68:71], v[76:79]
    v_mfma_f32_16x16x32_bf16 v[80:83], v[36:39], v[68:71], v[80:83]
    s_waitcnt lgkmcnt(0)
    v_mfma_f32_16x16x32_bf16 v[76:79], v[24:27], v[72:75], v[76:79]
    v_mfma_f32_16x16x32_bf16 v[80:83], v[40:43], v[72:75], v[80:83]
    s_cmp_lg_u32 s21, 0
    s_cbranch_scc1 L_x2km_28_s
    s_mov_b64 exec, 1
    v_mov_b32 v6, 0
    s_lshl_b32 s28, s22, 7
    s_add_u32 s28, s28, 46997504
    s_mov_b32 s29, 0
L_x2km_28:
    buffer_load_dword v7, v6, s[4:7], s28 offen sc0 sc1
    s_waitcnt vmcnt(0)
    v_readfirstlane_b32 s30, v7
    s_add_u32 s29, s29, 1
    s_cmp_gt_u32 s29, 0x80000
    s_cbranch_scc1 L_x2km_28_d
    s_cmp_gt_u32 s30, s40
    s_cbranch_scc1 L_x2km_28_d
    s_add_u32 s30, s30, 2
    s_cmp_gt_u32 s30, s40
    s_cbranch_scc1 L_x2km_28_n
    s_add_u32 s30, s30, 2
    s_cmp_gt_u32 s30, s40
    s_cbranch_scc1 L_x2km_28_m
    s_sleep 127
    s_branch L_x2km_28
L_x2km_28_m:
    s_sleep 16
    s_branch L_x2km_28
L_x2km_28_n:
    s_sleep 4
    s_branch L_x2km_28
L_x2km_28_d:
    s_mov_b64 exec, s[26:27]
L_x2km_28_s:
    s_waitcnt vmcnt(0)
    s_barrier
    s_lshl_b32 s28, s40, 16
    s_lshl_b32 s29, s22, 11
    s_add_u32 s28, s28, s29
    s_lshl_b32 s29, s21, 9
    s_add_u32 s29, s29, s28
    s_add_u32 s29, s29, 33554432
    v_lshrrev_b32 v6, 2, v0
    buffer_load_dword v8, v6, s[4:7], s29 offen offset:0 sc1
    buffer_load_dword v9, v6, s[4:7], s29 offen offset:256 sc1
    s_lshl_b32 s29, s45, 10
    s_add_u32 s29, s29, s28
    s_add_u32 s29, s29, 50331648
    buffer_load_dword v104, v6, s[4:7], s29 offen offset:0 sc1
    v_mov_b32 v105, 0
    buffer_load_dword v106, v6, s[4:7], s29 offen offset:256 sc1
    v_mov_b32 v107, 0
    buffer_load_dword v108, v6, s[4:7], s29 offen offset:512 sc1
    v_mov_b32 v109, 0
    buffer_load_dword v110, v6, s[4:7], s29 offen offset:768 sc1
    v_mov_b32 v111, 0
    v_and_b32 v10, 0xf0, v0
    v_lshlrev_b32 v10, 1, v10
    v_lshrrev_b32 v7, 8, v0
    v_lshlrev_b32 v7, 3, v7
    v_add_u32 v10, v10, v7
    s_lshl_b32 s29, s21, 10
    s_add_u32 s29, s29, 73728
    v_add_u32 v10, s29, v10
    s_waitcnt vmcnt(0)
    ds_write_b32 v10, v8 offset:0
    ds_write_b32 v10, v9 offset:512
    s_waitcnt lgkmcnt(0)
    s_barrier
    v_lshrrev_b32 v6, 1, v0
    v_add_u32 v6, 73728, v6
    ds_read_b64_tr_b16 v[88:89], v6 offset:0
    ds_read_b64_tr_b16 v[90:91], v6 offset:512
    ds_read_b64_tr_b16 v[92:93], v6 offset:1024
    ds_read_b64_tr_b16 v[94:95], v6 offset:1536
    ds_read_b64_tr_b16 v[96:97], v6 offset:2048
    ds_read_b64_tr_b16 v[98:99], v6 offset:2560
    ds_read_b64_tr_b16 v[100:101], v6 offset:3072
    ds_read_b64_tr_b16 v[102:103], v6 offset:3584
    s_waitcnt lgkmcnt(6)
    v_mfma_f32_16x16x32_bf16 v[84:87], v[88:91], v[60:63], 0
    s_waitcnt lgkmcnt(4)
    v_mfma_f32_16x16x32_bf16 v[84:87], v[92:95], v[64:67], v[84:87]
    s_waitcnt lgkmcnt(2)
    v_mfma_f32_16x16x32_bf16 v[84:87], v[96:99], v[68:71], v[84:87]
    s_waitcnt lgkmcnt(0)
    v_mfma_f32_16x16x32_bf16 v[84:87], v[100:103], v[72:75], v[84:87]
    v_mov_b32 v11, 0xff800000
    v_cmp_gt_i32 vcc, 0, v3
    s_nop 1
    v_cndmask_b32 v76, v76, v11, vcc
    v_cmp_gt_i32 vcc, 1, v3
    s_nop 1
    v_cndmask_b32 v77, v77, v11, vcc
    v_cmp_gt_i32 vcc, 2, v3
    s_nop 1
    v_cndmask_b32 v78, v78, v11, vcc
    v_cmp_gt_i32 vcc, 3, v3
    s_nop 1
    v_cndmask_b32 v79, v79, v11, vcc
    v_cmp_gt_i32 vcc, 16, v3
    s_nop 1
    v_cndmask_b32 v80, v80, v11, vcc
    v_cmp_gt_i32 vcc, 17, v3
    s_nop 1
    v_cndmask_b32 v81, v81, v11, vcc
    v_cmp_gt_i32 vcc, 18, v3
    s_nop 1
    v_cndmask_b32 v82, v82, v11, vcc
    v_cmp_gt_i32 vcc, 19, v3
    s_nop 1
    v_cndmask_b32 v83, v83, v11, vcc
    s_nop 1
    v_max3_f32 v6, v76, v77, v78
    v_max3_f32 v7, v80, v81, v82
    v_max3_f32 v6, v6, v79, v83
    v_max3_f32 v7, v7, v84, v85
    v_max_f32 v6, v6, v7
    v_mov_b32 v7, v6
    s_nop 1
    v_permlane16_swap_b32 v6, v7
    v_max_f32 v6, v6, v7
    v_mov_b32 v7, v6
    s_nop 1
    v_permlane32_swap_b32 v6, v7
    v_max_f32 v6, v6, v7
    v_mul_f32 v6, s52, v6
    v_fma_f32 v76, v76, s52, -v6
    v_fma_f32 v77, v77, s52, -v6
    v_fma_f32 v78, v78, s52, -v6
    v_fma_f32 v79, v79, s52, -v6
    v_fma_f32 v80, v80, s52, -v6
    v_fma_f32 v81, v81, s52, -v6
    v_fma_f32 v82, v82, s52, -v6
    v_fma_f32 v83, v83, s52, -v6
    v_fma_f32 v84, v84, s52, -v6
    v_fma_f32 v85, v85, s52, -v6
    v_exp_f32 v76, v76
    v_exp_f32 v77, v77
    v_exp_f32 v78, v78
    v_exp_f32 v79, v79
    v_exp_f32 v80, v80
    v_exp_f32 v81, v81
    v_exp_f32 v82, v82
    v_exp_f32 v83, v83
    v_exp_f32 v84, v84
    v_exp_f32 v85, v85
    s_nop 0
    v_add_f32 v8, v76, v77
    v_add_f32 v9, v78, v79
    v_add_f32 v8, v8, v80
    v_add_f32 v9, v9, v81
    v_add_f32 v8, v8, v82
    v_add_f32 v9, v9, v83
    v_add_f32 v8, v8, v84
    v_add_f32 v9, v9, v85
    v_add_f32 v8, v8, v9
    v_cvt_pk_bf16_f32 v76, v76, v77
    v_cvt_pk_bf16_f32 v77, v78, v79
    v_cvt_pk_bf16_f32 v78, v80, v81
    v_cvt_pk_bf16_f32 v79, v82, v83
    v_cvt_pk_bf16_f32 v86, v84, v85
    v_mov_b32 v87, 0
    v_mov_b32 v9, v8
    s_nop 1
    v_permlane16_swap_b32 v8, v9
    v_add_f32 v8, v8, v9
    v_mov_b32 v9, v8
    s_nop 1
    v_permlane32_swap_b32 v8, v9
    v_add_f32 v8, v8, v9
    v_rcp_f32 v8, v8
    v_mfma_f32_16x16x32_bf16 v[112:115], v[44:47], v[76:79], 0
    v_mfma_f32_16x16x32_bf16 v[116:119], v[48:51], v[76:79], 0
    v_mfma_f32_16x16x32_bf16 v[120:123], v[52:55], v[76:79], 0
    v_mfma_f32_16x16x32_bf16 v[124:127], v[56:59], v[76:79], 0
    v_mfma_f32_16x16x16_bf16 v[112:115], v[104:105], v[86:87], v[112:115]
    v_mfma_f32_16x16x16_bf16 v[116:119], v[106:107], v[86:87], v[116:119]
    v_mfma_f32_16x16x16_bf16 v[120:123], v[108:109], v[86:87], v[120:123]
    v_mfma_f32_16x16x16_bf16 v[124:127], v[110:111], v[86:87], v[124:127]
    s_nop 7
    v_mul_f32 v112, v112, v8
    v_mul_f32 v113, v113, v8
    v_mul_f32 v114, v114, v8
    v_mul_f32 v115, v115, v8
    v_mul_f32 v116, v116, v8
    v_mul_f32 v117, v117, v8
    v_mul_f32 v118, v118, v8
    v_mul_f32 v119, v119, v8
    v_mul_f32 v120, v120, v8
    v_mul_f32 v121, v121, v8
    v_mul_f32 v122, v122, v8
    v_mul_f32 v123, v123, v8
    v_mul_f32 v124, v124, v8
    v_mul_f32 v125, v125, v8
    v_mul_f32 v126, v126, v8
    v_mul_f32 v127, v127, v8
    v_cvt_pk_bf16_f32 v60, v112, v113
    v_cvt_pk_bf16_f32 v61, v114, v115
    v_cvt_pk_bf16_f32 v62, v116, v117
    v_cvt_pk_bf16_f32 v63, v118, v119
    v_cvt_pk_bf16_f32 v64, v120, v121
    v_cvt_pk_bf16_f32 v65, v122, v123
    v_cvt_pk_bf16_f32 v66, v124, v125
    v_cvt_pk_bf16_f32 v67, v126, v127
    s_lshl_b32 s28, s44, 12
    s_lshl_b32 s29, s45, 11
    s_add_u32 s28, s28, s29
    s_add_u32 s28, s28, 77824
    v_add_u32 v2, s28, v0
    ds_write_b128 v2, v[60:63] offset:0
    ds_write_b128 v2, v[64:67] offset:1024
    s_waitcnt lgkmcnt(0)
    s_barrier
    v_add_u32 v2, 77824, v0
    s_add_u32 s33, s46, s47
    ds_read_b128 v[44:47], v2 offset:0
    ds_read_b128 v[48:51], v2 offset:1024
    ds_read_b128 v[52:55], v2 offset:2048
    ds_read_b128 v[56:59], v2 offset:3072
    s_waitcnt lgkmcnt(3)
    v_mfma_f32_16x16x32_bf16 v[12:15], v[44:47], v[128:131], 0
    v_mfma_f32_16x16x32_bf16 v[16:19], v[44:47], v[144:147], 0
    v_mfma_f32_16x16x32_bf16 v[20:23], v[44:47], v[160:163], 0
    v_mfma_f32_16x16x32_bf16 v[24:27], v[44:47], v[176:179], 0
    v_mfma_f32_16x16x32_bf16 v[28:31], v[44:47], v[192:195], 0
    v_mfma_f32_16x16x32_bf16 v[32:35], v[44:47], v[208:211], 0
    v_mfma_f32_16x16x32_bf16 v[36:39], v[44:47], v[224:227], 0
    v_mfma_f32_16x16x32_bf16 v[40:43], v[44:47], v[240:243], 0
    s_waitcnt lgkmcnt(2)
    v_mfma_f32_16x16x32_bf16 v[12:15], v[48:51], v[132:135], v[12:15]
    v_mfma_f32_16x16x32_bf16 v[16:19], v[48:51], v[148:151], v[16:19]
    v_mfma_f32_16x16x32_bf16 v[20:23], v[48:51], v[164:167], v[20:23]
    v_mfma_f32_16x16x32_bf16 v[24:27], v[48:51], v[180:183], v[24:27]
    v_mfma_f32_16x16x32_bf16 v[28:31], v[48:51], v[196:199], v[28:31]
    v_mfma_f32_16x16x32_bf16 v[32:35], v[48:51], v[212:215], v[32:35]
    v_mfma_f32_16x16x32_bf16 v[36:39], v[48:51], v[228:231], v[36:39]
    v_mfma_f32_16x16x32_bf16 v[40:43], v[48:51], v[244:247], v[40:43]
    s_waitcnt lgkmcnt(1)
    v_mfma_f32_16x16x32_bf16 v[12:15], v[52:55], v[136:139], v[12:15]
    v_mfma_f32_16x16x32_bf16 v[16:19], v[52:55], v[152:155], v[16:19]
    v_mfma_f32_16x16x32_bf16 v[20:23], v[52:55], v[168:171], v[20:23]
    v_mfma_f32_16x16x32_bf16 v[24:27], v[52:55], v[184:187], v[24:27]
    v_mfma_f32_16x16x32_bf16 v[28:31], v[52:55], v[200:203], v[28:31]
    v_mfma_f32_16x16x32_bf16 v[32:35], v[52:55], v[216:219], v[32:35]
    v_mfma_f32_16x16x32_bf16 v[36:39], v[52:55], v[232:235], v[36:39]
    v_mfma_f32_16x16x32_bf16 v[40:43], v[52:55], v[248:251], v[40:43]
    s_waitcnt lgkmcnt(0)
    v_mfma_f32_16x16x32_bf16 v[12:15], v[56:59], v[140:143], v[12:15]
    v_mfma_f32_16x16x32_bf16 v[16:19], v[56:59], v[156:159], v[16:19]
    v_mfma_f32_16x16x32_bf16 v[20:23], v[56:59], v[172:175], v[20:23]
    v_mfma_f32_16x16x32_bf16 v[24:27], v[56:59], v[188:191], v[24:27]
    v_mfma_f32_16x16x32_bf16 v[28:31], v[56:59], v[204:207], v[28:31]
    v_mfma_f32_16x16x32_bf16 v[32:35], v[56:59], v[220:223], v[32:35]
    v_mfma_f32_16x16x32_bf16 v[36:39], v[56:59], v[236:239], v[36:39]
    v_mfma_f32_16x16x32_bf16 v[40:43], v[56:59], v[252:255], v[40:43]
    s_nop 7
    v_cvt_pk_bf16_f32 v60, v12, v13
    v_cvt_pk_bf16_f32 v61, v14, v15
    v_cvt_pk_bf16_f32 v62, v16, v17
    v_cvt_pk_bf16_f32 v63, v18, v19
    s_lshl_b32 s28, s21, 17
    s_add_u32 s28, s28, s33
    s_add_u32 s28, s28, 0
    buffer_store_dwordx4 v[60:63], v4, s[4:7], s28 offen
    v_cvt_pk_bf16_f32 v64, v20, v21
    v_cvt_pk_bf16_f32 v65, v22, v23
    v_cvt_pk_bf16_f32 v66, v24, v25
    v_cvt_pk_bf16_f32 v67, v26, v27
    s_lshl_b32 s28, s21, 17
    s_add_u32 s28, s28, s33
    s_add_u32 s28, s28, 32768
    buffer_store_dwordx4 v[64:67], v4, s[4:7], s28 offen
    v_cvt_pk_bf16_f32 v68, v28, v29
    v_cvt_pk_bf16_f32 v69, v30, v31
    v_cvt_pk_bf16_f32 v70, v32, v33
    v_cvt_pk_bf16_f32 v71, v34, v35
    s_lshl_b32 s28, s21, 17
    s_add_u32 s28, s28, s33
    s_add_u32 s28, s28, 65536
    buffer_store_dwordx4 v[68:71], v4, s[4:7], s28 offen
    v_cvt_pk_bf16_f32 v72, v36, v37
    v_cvt_pk_bf16_f32 v73, v38, v39
    v_cvt_pk_bf16_f32 v74, v40, v41
    v_cvt_pk_bf16_f32 v75, v42, v43
    s_lshl_b32 s28, s21, 17
    s_add_u32 s28, s28, s33
    s_add_u32 s28, s28, 98304
    buffer_store_dwordx4 v[72:75], v4, s[4:7], s28 offen
    s_nop 1
    ds_read_b128 v[44:47], v2 offset:4096
    ds_read_b128 v[48:51], v2 offset:5120
    ds_read_b128 v[52:55], v2 offset:6144
    ds_read_b128 v[56:59], v2 offset:7168
    s_waitcnt lgkmcnt(3)
    v_mfma_f32_16x16x32_bf16 v[12:15], v[44:47], v[128:131], 0
    v_mfma_f32_16x16x32_bf16 v[16:19], v[44:47], v[144:147], 0
    v_mfma_f32_16x16x32_bf16 v[20:23], v[44:47], v[160:163], 0
    v_mfma_f32_16x16x32_bf16 v[24:27], v[44:47], v[176:179], 0
    v_mfma_f32_16x16x32_bf16 v[28:31], v[44:47], v[192:195], 0
    v_mfma_f32_16x16x32_bf16 v[32:35], v[44:47], v[208:211], 0
    v_mfma_f32_16x16x32_bf16 v[36:39], v[44:47], v[224:227], 0
    v_mfma_f32_16x16x32_bf16 v[40:43], v[44:47], v[240:243], 0
    s_waitcnt lgkmcnt(2)
    v_mfma_f32_16x16x32_bf16 v[12:15], v[48:51], v[132:135], v[12:15]
    v_mfma_f32_16x16x32_bf16 v[16:19], v[48:51], v[148:151], v[16:19]
    v_mfma_f32_16x16x32_bf16 v[20:23], v[48:51], v[164:167], v[20:23]
    v_mfma_f32_16x16x32_bf16 v[24:27], v[48:51], v[180:183], v[24:27]
    v_mfma_f32_16x16x32_bf16 v[28:31], v[48:51], v[196:199], v[28:31]
    v_mfma_f32_16x16x32_bf16 v[32:35], v[48:51], v[212:215], v[32:35]
    v_mfma_f32_16x16x32_bf16 v[36:39], v[48:51], v[228:231], v[36:39]
    v_mfma_f32_16x16x32_bf16 v[40:43], v[48:51], v[244:247], v[40:43]
    s_waitcnt lgkmcnt(1)
    v_mfma_f32_16x16x32_bf16 v[12:15], v[52:55], v[136:139], v[12:15]
    v_mfma_f32_16x16x32_bf16 v[16:19], v[52:55], v[152:155], v[16:19]
    v_mfma_f32_16x16x32_bf16 v[20:23], v[52:55], v[168:171], v[20:23]
    v_mfma_f32_16x16x32_bf16 v[24:27], v[52:55], v[184:187], v[24:27]
    v_mfma_f32_16x16x32_bf16 v[28:31], v[52:55], v[200:203], v[28:31]
    v_mfma_f32_16x16x32_bf16 v[32:35], v[52:55], v[216:219], v[32:35]
    v_mfma_f32_16x16x32_bf16 v[36:39], v[52:55], v[232:235], v[36:39]
    v_mfma_f32_16x16x32_bf16 v[40:43], v[52:55], v[248:251], v[40:43]
    s_waitcnt lgkmcnt(0)
    v_mfma_f32_16x16x32_bf16 v[12:15], v[56:59], v[140:143], v[12:15]
    v_mfma_f32_16x16x32_bf16 v[16:19], v[56:59], v[156:159], v[16:19]
    v_mfma_f32_16x16x32_bf16 v[20:23], v[56:59], v[172:175], v[20:23]
    v_mfma_f32_16x16x32_bf16 v[24:27], v[56:59], v[188:191], v[24:27]
    v_mfma_f32_16x16x32_bf16 v[28:31], v[56:59], v[204:207], v[28:31]
    v_mfma_f32_16x16x32_bf16 v[32:35], v[56:59], v[220:223], v[32:35]
    v_mfma_f32_16x16x32_bf16 v[36:39], v[56:59], v[236:239], v[36:39]
    v_mfma_f32_16x16x32_bf16 v[40:43], v[56:59], v[252:255], v[40:43]
    s_nop 7
    v_cvt_pk_bf16_f32 v60, v12, v13
    v_cvt_pk_bf16_f32 v61, v14, v15
    v_cvt_pk_bf16_f32 v62, v16, v17
    v_cvt_pk_bf16_f32 v63, v18, v19
    s_lshl_b32 s28, s21, 17
    s_add_u32 s28, s28, s33
    s_add_u32 s28, s28, 524288
    buffer_store_dwordx4 v[60:63], v4, s[4:7], s28 offen
    v_cvt_pk_bf16_f32 v64, v20, v21
    v_cvt_pk_bf16_f32 v65, v22, v23
    v_cvt_pk_bf16_f32 v66, v24, v25
    v_cvt_pk_bf16_f32 v67, v26, v27
    s_lshl_b32 s28, s21, 17
    s_add_u32 s28, s28, s33
    s_add_u32 s28, s28, 557056
    buffer_store_dwordx4 v[64:67], v4, s[4:7], s28 offen
    v_cvt_pk_bf16_f32 v68, v28, v29
    v_cvt_pk_bf16_f32 v69, v30, v31
    v_cvt_pk_bf16_f32 v70, v32, v33
    v_cvt_pk_bf16_f32 v71, v34, v35
    s_lshl_b32 s28, s21, 17
    s_add_u32 s28, s28, s33
    s_add_u32 s28, s28, 589824
    buffer_store_dwordx4 v[68:71], v4, s[4:7], s28 offen
    v_cvt_pk_bf16_f32 v72, v36, v37
    v_cvt_pk_bf16_f32 v73, v38, v39
    v_cvt_pk_bf16_f32 v74, v40, v41
    v_cvt_pk_bf16_f32 v75, v42, v43
    s_lshl_b32 s28, s21, 17
    s_add_u32 s28, s28, s33
    s_add_u32 s28, s28, 622592
    buffer_store_dwordx4 v[72:75], v4, s[4:7], s28 offen
    s_nop 1
    s_waitcnt vmcnt(0)
    s_barrier
    s_cmp_lg_u32 s21, 0
    s_cbranch_scc1 L_x2f_29
    s_add_u32 s28, s41, 1
    v_mov_b32 v6, s28
    v_mov_b32 v7, 0
    s_lshl_b32 s28, s23, 7
    s_lshl_b32 s29, s22, 2
    s_add_u32 s28, s28, s29
    s_add_u32 s28, s28, 46991360
    s_mov_b64 exec, 1
    buffer_store_dword v6, v7, s[4:7], s28 offen
    s_mov_b64 exec, s[26:27]
L_x2f_29:
    v_lshrrev_b32 v6, 2, v0
    v_and_b32 v6, 127, v6
    s_lshl_b32 s28, s23, 7
    s_add_u32 s28, s28, 46991360
    s_mov_b32 s29, 0
    v_add_u32 v9, 86016, v0
    ds_read_b128 v[44:47], v9
L_x2r_30:
    buffer_load_dword v7, v6, s[4:7], s28 offen sc1
    s_waitcnt vmcnt(0)
    v_cmp_ge_u32 vcc, s41, v7
    s_add_u32 s29, s29, 1
    s_cmp_gt_u32 s29, 0x80000
    s_cbranch_scc1 L_x2r_30_d
    s_cbranch_vccnz L_x2r_30
L_x2r_30_d:
    s_lshl_b32 s28, s22, 2
    s_add_u32 s28, s28, s21
    s_lshl_b32 s28, s28, 13
    s_add_u32 s28, s28, s33
    s_add_u32 s29, s28, 4096
    buffer_load_dwordx4 v[12:15], v0, s[4:7], s28 offen offset:0 sc1
    buffer_load_dwordx4 v[16:19], v0, s[4:7], s28 offen offset:1024 sc1
    buffer_load_dwordx4 v[20:23], v0, s[4:7], s28 offen offset:2048 sc1
    buffer_load_dwordx4 v[24:27], v0, s[4:7], s28 offen offset:3072 sc1
    buffer_load_dwordx4 v[28:31], v0, s[4:7], s29 offen offset:0 sc1
    buffer_load_dwordx4 v[32:35], v0, s[4:7], s29 offen offset:1024 sc1
    buffer_load_dwordx4 v[36:39], v0, s[4:7], s29 offen offset:2048 sc1
    buffer_load_dwordx4 v[40:43], v0, s[4:7], s29 offen offset:3072 sc1
    s_waitcnt lgkmcnt(0)
    s_waitcnt vmcnt(7)
    v_mfma_f32_16x16x32_bf16 v[48:51], v[12:15], v[44:47], 0
    s_waitcnt vmcnt(6)
    v_mfma_f32_16x16x32_bf16 v[48:51], v[16:19], v[44:47], v[48:51]
    s_waitcnt vmcnt(5)
    v_mfma_f32_16x16x32_bf16 v[48:51], v[20:23], v[44:47], v[48:51]
    s_waitcnt vmcnt(4)
    v_mfma_f32_16x16x32_bf16 v[48:51], v[24:27], v[44:47], v[48:51]
    s_waitcnt vmcnt(3)
    v_mfma_f32_16x16x32_bf16 v[48:51], v[28:31], v[44:47], v[48:51]
    s_waitcnt vmcnt(2)
    v_mfma_f32_16x16x32_bf16 v[48:51], v[32:35], v[44:47], v[48:51]
    s_waitcnt vmcnt(1)
    v_mfma_f32_16x16x32_bf16 v[48:51], v[36:39], v[44:47], v[48:51]
    s_waitcnt vmcnt(0)
    v_mfma_f32_16x16x32_bf16 v[48:51], v[40:43], v[44:47], v[48:51]
    v_lshrrev_b32 v6, 8, v0
    v_lshlrev_b32 v6, 2, v6
    v_bfe_u32 v7, v0, 4, 2
    v_add_u32 v6, v6, v7
    v_lshlrev_b32 v6, 11, v6
    v_bfe_u32 v7, v0, 6, 1
    v_lshlrev_b32 v7, 3, v7
    v_add_u32 v6, v6, v7
    s_lshr_b32 s28, s22, 4
    s_lshl_b32 s28, s28, 4
    s_lshl_b32 s29, s40, 5
    s_add_u32 s28, s28, s29
    s_lshl_b32 s28, s28, 11
    s_bfe_u32 s29, s22, 0x20002
    s_lshl_b32 s29, s29, 8
    s_add_u32 s28, s28, s29
    s_bfe_u32 s29, s22, 0x10001
    s_lshl_b32 s29, s29, 7
    s_add_u32 s28, s28, s29
    s_and_b32 s29, s22, 1
    s_lshl_b32 s29, s29, 4
    s_add_u32 s28, s28, s29
    s_lshl_b32 s29, s21, 5
    s_add_u32 s28, s28, s29
    s_add_u32 s28, s28, 1024
    s_nop 3
    v_cvt_pk_bf16_f32 v48, v48, v49
    v_cvt_pk_bf16_f32 v49, v50, v51
    v_and_b32 v7, 128, v0
    v_cmp_eq_u32 vcc, 0, v7
    s_nop 1
    s_mov_b64 exec, vcc
    buffer_store_dwordx2 v[48:49], v6, s[16:19], s28 offen
    s_mov_b64 exec, s[26:27]
    s_add_u32 s40, s40, 7
    s_xor_b32 s43, s43, 32768
    s_xor_b32 s47, s47, 0x100000
    s_add_u32 s41, s41, 1
    s_cmp_lt_u32 s41, s42
    s_cbranch_scc1 L_x2
    s_waitcnt vmcnt(0)
    s_branch L_end
L_end:
    s_endpgm
.section .rodata,"a"
.p2align 6
.amdhsa_kernel concat_heads__ssm_conv_h3__memory_aug_recurrent_mem_tr__prompt_kernel
  .amdhsa_next_free_vgpr 512
  .amdhsa_next_free_sgpr 102
  .amdhsa_accum_offset 256
  .amdhsa_group_segment_fixed_size 0
  .amdhsa_kernarg_size 128
  .amdhsa_user_sgpr_count 2
  .amdhsa_user_sgpr_kernarg_segment_ptr 1
  .amdhsa_system_sgpr_workgroup_id_x 1
.end_amdhsa_kernel
```
